```python
import torch

def _softmax(x, axis=-1):
    return torch.softmax(x, dim=axis)
def _gelu(x):
    return torch.nn.functional.gelu(x, approximate="tanh")
def _silu(x):
    return torch.nn.functional.silu(x)
def _sigmoid(x):
    return torch.sigmoid(x)
def _layernorm(x, axis=-1, eps=1e-5):
    m = x.mean(dim=axis, keepdim=True)
    v = x.var(dim=axis, keepdim=True, unbiased=False)
    return (x - m) / torch.sqrt(v + eps)
def _scatter_add(tgt, idx, src, axis=0):
    return tgt.clone().index_add_(axis, idx, src)
def _segment_sum(src, seg, n):
    out = torch.zeros((n,) + src.shape[1:], dtype=src.dtype)
    return out.index_add_(0, seg, src)
def _pad(x, pw):
    flat = tuple(v for pair in reversed(pw) for v in pair)
    return torch.nn.functional.pad(x, flat)

kernel_name = 'parallel_sum__linear_kernel_hedgehog__glu_gated_glu__prompt'

def setup_inputs():

    _w = (lambda a: (lambda t: t.to(torch.bfloat16) if t.is_floating_point() else t)(torch.as_tensor(a)))
    def _A_setup():
        B, S, D, H = 1, 2048, 512, 32
        Dh = D // H
        return {
            "x": _w((lambda *s: torch.randn(*s, dtype=torch.bfloat16) * 0.05)(B, S, D)),
            "wqkv": _w((lambda *s: torch.randn(*s, dtype=torch.bfloat16) * 0.4)(D, 3 * D)),
            "w_phi": _w((lambda *s: torch.randn(*s, dtype=torch.bfloat16) * 0.4)(H, Dh, Dh) * (Dh ** -0.5)),
            "wo": _w((lambda *s: torch.randn(*s, dtype=torch.bfloat16) * 0.1)(D, D)),
        }
    _A_in = _A_setup()

    def _B_setup():
        B, S, D, F = 1, 2048, 512, 1792
        return {
            "x": _w((lambda *s: torch.randn(*s, dtype=torch.bfloat16) * 0.05)(B, S, D)),
            "w_gate": _w((lambda *s: torch.randn(*s, dtype=torch.bfloat16) * 0.05)(D, F)),
            "w_up": _w((lambda *s: torch.randn(*s, dtype=torch.bfloat16) * 0.05)(D, F)),
            "w_down": _w((lambda *s: torch.randn(*s, dtype=torch.bfloat16) * 0.05)(F, D)),
        }
    _B_in = _B_setup()

    return {
        "A_x": _A_in["x"],
        "A_wqkv": _A_in["wqkv"],
        "A_w_phi": _A_in["w_phi"],
        "A_wo": _A_in["wo"],
        "B_x": _B_in["x"],
        "B_w_gate": _B_in["w_gate"],
        "B_w_up": _B_in["w_up"],
        "B_w_down": _B_in["w_down"],
    }

def reference(A_x, A_wqkv, A_w_phi, A_wo, B_x, B_w_gate, B_w_up, B_w_down):
    def _A_ref(x, wqkv, w_phi, wo):
        B, S, D = x.shape
        H = 32; Dh = D // H
        qkv = (lambda x, *d: x.permute(*d))((x @ wqkv).reshape(B, S, 3, H, Dh), 2, 0, 3, 1, 4)
        q, k, v = qkv[0], qkv[1], qkv[2]
        pq = torch.einsum("bhsd,hdf->bhsf", q, w_phi)
        pk = torch.einsum("bhsd,hdf->bhsf", k, w_phi)
        phi_q = torch.concatenate([_softmax(pq, axis=-1), _softmax(-pq, axis=-1)], axis=-1)
        phi_k = torch.concatenate([_softmax(pk, axis=-1), _softmax(-pk, axis=-1)], axis=-1)
        kv = torch.einsum("bhsf,bhsd->bhfd", phi_k, v)
        z  = torch.einsum("bhsf->bhf", phi_k)
        num = torch.einsum("bhqf,bhfd->bhqd", phi_q, kv)
        den = torch.einsum("bhqf,bhf->bhq", phi_q, z)[..., None] + 1e-6
        o = num / den
        return (lambda x, *d: x.permute(*d))(o, 0, 2, 1, 3).reshape(B, S, D) @ wo

    def _B_ref(x, w_gate, w_up, w_down):
        g = torch.einsum("bsd,df->bsf", x, w_gate)
        u = torch.einsum("bsd,df->bsf", x, w_up)
        h = _sigmoid(g) * u
        return torch.einsum("bsf,fd->bsd", h, w_down)

    x = A_x
    xn = _layernorm(x, axis=-1)
    return x + _A_ref(xn, A_wqkv, A_w_phi, A_wo) + _B_ref(xn, B_w_gate, B_w_up, B_w_down)
```

```asm
; @launch grid=(256,1,1) block=(512,1,1) lds=163840
.amdgcn_target "amdgcn-amd-amdhsa--gfx950"
.text
.globl parallel_sum__linear_kernel_hedgehog__glu_gated_glu__prompt_kernel
.p2align 8
.type parallel_sum__linear_kernel_hedgehog__glu_gated_glu__prompt_kernel,@function
parallel_sum__linear_kernel_hedgehog__glu_gated_glu__prompt_kernel:
  s_cmp_ge_u32 s2, 256
  s_cbranch_scc1 L_END
  s_load_dwordx2 s[4:5], s[0:1], 0
  s_load_dwordx2 s[8:9], s[0:1], 8
  s_load_dwordx2 s[20:21], s[0:1], 40
  s_load_dwordx2 s[24:25], s[0:1], 48
  s_load_dwordx2 s[40:41], s[0:1], 80
  s_load_dwordx2 s[36:37], s[0:1], 72
  s_load_dwordx2 s[12:13], s[0:1], 16
  s_load_dwordx2 s[16:17], s[0:1], 24
  s_load_dwordx2 s[28:29], s[0:1], 56
  s_load_dwordx2 s[32:33], s[0:1], 64
  s_getpc_b64 s[68:69]
  s_and_b32 s68, s68, 0xffffff00
  s_and_b32 s74, s2, 0xf8
  v_lshrrev_b32 v12, 6, v0
  v_add_lshl_u32 v12, v12, s74, 7
  v_and_b32 v1, 1, v0
  v_lshl_add_u32 v12, v1, 15, v12
  v_min_u32 v12, 38912, v12
  global_load_dword v12, v12, s[68:69]
  v_lshrrev_b32 v1, 6, v0
  v_and_b32 v0, 63, v0
  v_readfirstlane_b32 s44, v1
  s_mov_b32 s6, 2097152
  s_mov_b32 s7, 0x20000
  s_mov_b32 s10, 1572864
  s_mov_b32 s11, 0x20000
  s_mov_b32 s14, 16384
  s_mov_b32 s15, 0x20000
  s_mov_b32 s18, 524288
  s_mov_b32 s19, 0x20000
  s_mov_b32 s22, 1835008
  s_mov_b32 s23, 0x20000
  s_mov_b32 s26, 1835008
  s_mov_b32 s27, 0x20000
  s_mov_b32 s30, 1835008
  s_mov_b32 s31, 0x20000
  s_mov_b32 s34, 2097152
  s_mov_b32 s35, 0x20000
  s_mov_b32 s38, 256
  s_mov_b32 s39, 0x20000
  s_mov_b32 s42, 10167296
  s_mov_b32 s43, 0x20000
  s_lshr_b32 s52, s2, 3
  s_and_b32 s58, s52, 7
  s_and_b32 s56, s2, 1
  s_lshl_b32 s56, s56, 3
  s_add_u32 s47, s56, s58
  s_lshr_b32 s57, s52, 3
  s_mul_i32 s56, s57, 0
  s_add_u32 s53, s58, s56
  s_and_b32 s53, s53, 7
  s_and_b32 s57, s57, 1
  s_and_b32 s56, s2, 6
  s_add_u32 s48, s56, s57
  s_lshr_b32 s56, s52, 4
  s_lshl_b32 s56, s56, 3
  s_add_u32 s56, s56, s48
  s_lshl_b32 s57, s47, 4
  s_add_u32 s56, s56, s57
  s_lshl_b32 s101, s56, 7
  s_add_u32 s101, s101, 10003456
  s_lshl_b32 s56, s56, 3
  s_add_u32 s56, s56, s44
  s_lshl_b32 s56, s56, 10
  v_lshlrev_b32 v1, 4, v0
  s_waitcnt lgkmcnt(0)
  buffer_load_dwordx4 v[64:67], v1, s[4:7], s56 offen
  s_or_b32 s56, s52, s44
  s_cmp_lg_u32 s56, 0
  s_cbranch_scc0 OTSK_1
TSK_1:
  s_add_u32 s56, s53, 0
  s_and_b32 s56, s56, 7
  s_lshl_b32 s85, s56, 7
  s_add_u32 s56, s53, 1
  s_and_b32 s56, s56, 7
  s_lshl_b32 s86, s56, 7
  s_add_u32 s56, s53, 2
  s_and_b32 s56, s56, 7
  s_lshl_b32 s87, s56, 7
  s_add_u32 s56, s53, 3
  s_and_b32 s56, s56, 7
  s_lshl_b32 s88, s56, 7
  s_add_u32 s56, s53, 4
  s_and_b32 s56, s56, 7
  s_lshl_b32 s89, s56, 7
  s_add_u32 s56, s53, 5
  s_and_b32 s56, s56, 7
  s_lshl_b32 s90, s56, 7
  s_add_u32 s56, s53, 6
  s_and_b32 s56, s56, 7
  s_lshl_b32 s91, s56, 7
  s_add_u32 s56, s53, 7
  s_and_b32 s56, s56, 7
  s_lshl_b32 s92, s56, 7
  v_lshrrev_b32 v2, 3, v0
  v_lshrrev_b32 v3, 4, v0
  v_and_b32 v4, 7, v0
  v_xor_b32 v3, v3, v4
  v_lshlrev_b32 v3, 4, v3
  v_lshl_add_u32 v3, v2, 10, v3
  s_lshl_b32 s58, s47, 17
  s_lshl_b32 s56, s44, 14
  s_add_u32 s58, s58, s56
  v_add_u32 v6, s58, v3
  v_xor_b32 v7, 8256, v6
  s_lshl_b32 s49, s44, 10
  s_lshl_b32 s50, s44, 11
  s_cmp_lt_u32 s52, 16
  s_cbranch_scc0 L_TYPEQ
  s_add_u32 m0, s50, 16384
  s_nop 0
  buffer_load_dwordx4 v6, s[4:7], s85 offen lds
  s_add_u32 m0, s50, 17408
  s_nop 0
  buffer_load_dwordx4 v7, s[4:7], s85 offen lds
  s_mul_i32 s77, s85, 1536
  s_mul_i32 s56, s44, 24576
  s_lshl_b32 s57, s48, 7
  s_add_u32 s56, s56, s57
  s_add_u32 s56, s56, 1024
  v_bfe_u32 v192, v0, 2, 3
  v_mul_u32_u24 v192, 3072, v192
  v_lshrrev_b32 v193, 5, v0
  v_lshl_add_u32 v192, v193, 6, v192
  v_and_b32 v193, 3, v0
  v_lshl_add_u32 v192, v193, 4, v192
  v_add_u32 v2, s56, v192
  v_xor_b32 v3, 32, v2
  v_add_u32 v3, 1024, v3
  s_add_u32 m0, s49, 81920
  s_nop 0
  buffer_load_dwordx4 v2, s[8:11], s77 offen lds
  s_add_u32 m0, s49, 90112
  s_nop 0
  buffer_load_dwordx4 v3, s[8:11], s77 offen lds
  s_mul_i32 s78, s86, 1536
  s_mul_i32 s79, s87, 1536
  s_mul_i32 s80, s88, 1536
  s_mul_i32 s81, s89, 1536
  s_mul_i32 s82, s90, 1536
  s_mul_i32 s83, s91, 1536
  s_mul_i32 s84, s92, 1536
  s_min_u32 s3, s44, 1
  s_lshl_b32 s3, s3, 30
  s_and_b32 s45, s44, 3
  s_lshr_b32 s46, s44, 2
  s_lshl_b32 s100, s46, 1
  s_xor_b32 s100, s100, s45
  v_bfe_u32 v240, v0, 4, 1
  v_lshrrev_b32 v241, 5, v0
  v_bfe_u32 v242, v0, 2, 2
  v_and_b32 v243, 3, v0
  v_lshlrev_b32 v243, 3, v243
  v_lshl_add_u32 v244, v242, 6, v243
  v_xor_b32 v245, s46, v240
  v_lshl_add_u32 v245, v245, 5, v244
  v_lshl_add_u32 v245, v240, 13, v245
  v_lshl_add_u32 v8, v241, 10, v245
  s_lshl_b32 s56, s100, 11
  v_add_u32 v8, s56, v8
  v_and_b32 v246, 31, v0
  v_bfe_u32 v247, v0, 1, 3
  v_xor_b32 v247, v247, v241
  s_lshl_b32 s57, s100, 1
  v_xor_b32 v247, s57, v247
  v_lshlrev_b32 v247, 4, v247
  v_lshl_add_u32 v11, v246, 7, v247
  s_lshl_b32 s57, s45, 12
  s_add_u32 s57, s57, 16384
  v_add_u32 v84, s57, v11
  v_xor_b32 v85, 32, v84
  v_xor_b32 v86, 64, v84
  v_xor_b32 v87, 96, v84
  v_bfe_u32 v247, v0, 2, 1
  s_add_u32 m0, s50, 32768
  s_nop 0
  buffer_load_dwordx4 v6, s[4:7], s86 offen lds
  v_cmp_eq_u32 vcc, v247, v240
  v_mov_b32 v22, 0x3f803f80
  s_nop 0
  v_cndmask_b32 v28, 0, v22, vcc
  v_cndmask_b32 v29, 0, v22, vcc
  v_cndmask_b32 v30, 0, v22, vcc
  v_cndmask_b32 v31, 0, v22, vcc
  s_cmp_lg_u32 s46, 0
  v_lshl_add_u32 v9, v241, 9, v245
  s_lshl_b32 s56, s100, 10
  v_add_u32 v9, s56, v9
  s_lshl_b32 s56, s48, 3
  s_add_u32 s56, s56, s44
  s_lshl_b32 s56, s56, 4
  s_add_u32 s56, s56, s47
  s_lshl_b32 s64, s56, 9
  s_add_u32 s64, s64, 9437184
  s_add_u32 m0, s50, 33792
  s_nop 0
  buffer_load_dwordx4 v7, s[4:7], s86 offen lds
  s_lshl_b32 s65, s56, 5
  s_add_u32 s65, s65, 9961472
  s_lshl_b32 s57, s44, 5
  s_add_u32 s56, s57, s85
  s_and_b32 s56, s56, 1023
  s_mul_i32 s93, s56, 1792
  s_add_u32 s56, s57, s87
  s_and_b32 s56, s56, 1023
  s_mul_i32 s94, s56, 1792
  s_add_u32 s56, s57, s89
  s_and_b32 s56, s56, 1023
  s_mul_i32 s95, s56, 1792
  s_add_u32 s56, s57, s91
  s_and_b32 s56, s56, 1023
  s_mul_i32 s96, s56, 1792
  s_mul_i32 s56, s44, 28672
  s_add_u32 m0, s49, 98304
  s_nop 0
  buffer_load_dwordx4 v2, s[8:11], s78 offen lds
  s_lshl_b32 s57, s48, 7
  s_add_u32 s56, s56, s57
  s_add_u32 s56, s56, 1024
  v_bfe_u32 v248, v0, 2, 3
  v_mul_u32_u24 v248, 3584, v248
  v_lshrrev_b32 v249, 5, v0
  v_lshl_add_u32 v248, v249, 6, v248
  v_and_b32 v249, 3, v0
  v_lshl_add_u32 v248, v249, 4, v248
  v_add_u32 v4, s56, v248
  v_xor_b32 v5, 32, v4
  s_lshl_b32 s99, s46, 11
  s_lshl_b32 s56, s45, 3
  s_add_u32 s99, s99, s56
  s_lshl_b32 s56, s47, 2
  s_add_u32 s56, s56, s45
  s_add_u32 m0, s49, 106496
  s_nop 0
  buffer_load_dwordx4 v3, s[8:11], s78 offen lds
  s_mul_i32 s56, s56, 147456
  s_lshl_b32 s57, s48, 2
  s_add_u32 s57, s57, s46
  s_lshl_b32 s58, s57, 10
  s_add_u32 s60, s56, s58
  s_lshl_b32 s57, s48, 1
  s_add_u32 s57, s57, s46
  s_lshl_b32 s58, s57, 10
  s_add_u32 s61, s56, s58
  s_lshl_b32 s63, s47, 9
  s_lshl_b32 s56, s48, 3
  s_add_u32 s63, s63, s56
  s_add_u32 s63, s63, 9994240
  s_lshl_b32 s59, s48, 7
  s_lshl_b32 s56, s47, 3
  s_add_u32 s59, s59, s56
  s_add_u32 s59, s59, 10002432
  s_and_b32 s56, s2, 7
  s_lshl_b32 s56, s56, 2
  s_and_b32 s57, s52, 3
  s_add_u32 s56, s56, s57
  s_lshr_b32 s76, s56, 1
  s_lshl_b32 s76, s76, 9
  s_lshr_b32 s57, s52, 2
  s_lshl_b32 s57, s57, 7
  s_lshl_b32 s73, s56, 16
  s_add_u32 s73, s73, s57
  s_lshl_b32 s58, s44, 13
  s_add_u32 s73, s73, s58
  s_lshl_b32 s58, s44, 14
  s_add_u32 s53, s58, s57
  s_lshl_b32 s56, s56, 1
  s_and_b32 s57, s44, 1
  s_add_u32 s56, s56, s57
  s_mul_i32 s62, s56, 147456
  s_lshr_b32 s57, s44, 1
  s_lshl_b32 s57, s57, 11
  s_add_u32 s62, s62, s57
  v_lshl_add_u32 v248, v241, 2, v242
  v_lshlrev_b32 v17, 5, v248
  v_lshl_add_u32 v17, v240, 4, v17
  v_and_b32 v248, 2, v0
  v_lshl_add_u32 v17, v248, 2, v17
  s_lshl_b32 s56, s46, 9
  v_add_u32 v17, s56, v17
  v_mul_u32_u24 v248, 0x8000, v247
  v_lshl_or_b32 v18, v248, 16, v248
  v_xor_b32 v247, v247, v241
  v_lshlrev_b32 v247, 5, v247
  v_lshl_add_u32 v19, v246, 6, v247
  s_lshl_b32 s56, s46, 13
  s_lshl_b32 s57, s45, 11
  s_add_u32 s56, s56, s57
  s_add_u32 s57, s56, 16384
  v_add_u32 v19, s57, v19
  v_lshlrev_b32 v247, 4, v241
  v_lshl_add_u32 v20, v246, 5, v247
  s_lshr_b32 s56, s56, 1
  s_add_u32 s56, s56, 49152
  v_add_u32 v20, s56, v20
  v_lshl_add_u32 v11, v240, 5, v244
  v_lshl_add_u32 v11, v241, 8, v11
  s_lshr_b32 s56, s44, 1
  s_lshl_b32 s56, s56, 12
  v_add_u32 v11, s56, v11
  s_lshl_b32 s56, s44, 8
  s_lshl_b32 s57, s48, 11
  s_add_u32 s57, s57, s56
  v_lshlrev_b32 v248, 2, v0
  s_add_u32 m0, s56, 512
  s_nop 0
  buffer_load_dword v248, s[12:15], s57 offen lds
  s_waitcnt vmcnt(9)
  v_dot2_f32_bf16 v68, v64, v22, 0
  v_dot2_f32_bf16 v69, v64, v64, 0
  v_dot2_f32_bf16 v68, v65, v22, v68
  v_dot2_f32_bf16 v69, v65, v65, v69
  v_dot2_f32_bf16 v68, v66, v22, v68
  v_dot2_f32_bf16 v69, v66, v66, v69
  v_dot2_f32_bf16 v68, v67, v22, v68
  v_dot2_f32_bf16 v69, v67, v67, v69
  s_nop 1
  v_add_f32_dpp v68, v68, v68 quad_perm:[1,0,3,2] row_mask:0xf bank_mask:0xf
  v_add_f32_dpp v69, v69, v69 quad_perm:[1,0,3,2] row_mask:0xf bank_mask:0xf
  s_nop 0
  v_add_f32_dpp v68, v68, v68 quad_perm:[2,3,0,1] row_mask:0xf bank_mask:0xf
  v_add_f32_dpp v69, v69, v69 quad_perm:[2,3,0,1] row_mask:0xf bank_mask:0xf
  s_nop 0
  v_add_f32_dpp v68, v68, v68 row_half_mirror row_mask:0xf bank_mask:0xf
  v_add_f32_dpp v69, v69, v69 row_half_mirror row_mask:0xf bank_mask:0xf
  s_nop 0
  v_add_f32_dpp v68, v68, v68 row_mirror row_mask:0xf bank_mask:0xf
  v_add_f32_dpp v69, v69, v69 row_mirror row_mask:0xf bank_mask:0xf
  v_mov_b32 v70, v68
  v_mov_b32 v71, v69
  s_nop 0
  v_permlane16_swap_b32 v68, v70
  v_permlane16_swap_b32 v69, v71
  v_add_f32 v68, v68, v70
  v_add_f32 v69, v69, v71
  v_mov_b32 v70, v68
  v_mov_b32 v71, v69
  s_nop 0
  v_permlane32_swap_b32 v68, v70
  v_permlane32_swap_b32 v69, v71
  v_add_f32 v68, v68, v70
  v_add_f32 v69, v69, v71
  v_mul_f32 v68, 0xbb000000, v68
  v_mul_f32 v69, 0x3b000000, v69
  v_mul_f32 v70, v68, v68
  v_sub_f32 v69, v69, v70
  v_max_f32 v69, 0, v69
  v_add_f32 v69, 0x3727c5ac, v69
  s_lshl_b32 s56, s44, 3
  v_mov_b32 v70, s56
  ds_write_b64 v70, v[68:69] offset:4096
  s_mov_b32 s0, 20000
  s_mov_b32 s67, 0
  s_waitcnt lgkmcnt(0)
  buffer_load_dwordx2 v[88:89], off, s[36:39], s3 sc1
  s_waitcnt vmcnt(6)
  s_barrier
  v_xor_b32 v10, 81920, v8
  ds_read_b128 v[128:131], v84 offset:0
  ds_read_b64_tr_b16 v[96:97], v10 offset:0
  ds_read_b64_tr_b16 v[98:99], v10 offset:256
  ds_read_b64_tr_b16 v[100:101], v10 offset:512
  ds_read_b64_tr_b16 v[102:103], v10 offset:768
  v_xor_b32 v10, 83968, v8
  ds_read_b128 v[132:135], v85 offset:0
  ds_read_b64_tr_b16 v[104:105], v10 offset:0
  ds_read_b64_tr_b16 v[106:107], v10 offset:256
  ds_read_b64_tr_b16 v[108:109], v10 offset:512
  ds_read_b64_tr_b16 v[110:111], v10 offset:768
  v_xor_b32 v10, 86016, v8
  ds_read_b128 v[136:139], v86 offset:0
  ds_read_b128 v[140:143], v87 offset:0
  s_waitcnt lgkmcnt(9)
  v_mfma_f32_32x32x16_bf16 v[32:47], v[96:99], v[128:131], 0
  ds_read_b64_tr_b16 v[112:113], v10 offset:0
  ds_read_b64_tr_b16 v[114:115], v10 offset:256
  v_and_b32 v82, 7, v0
  v_lshlrev_b32 v82, 3, v82
  ds_read_b64 v[80:81], v82 offset:4096
  s_add_u32 m0, s50, 49152
  s_nop 0
  buffer_load_dwordx4 v6, s[4:7], s87 offen lds
  v_mfma_f32_16x16x32_bf16 v[72:75], v[28:31], v[96:99], 0
  s_waitcnt lgkmcnt(10)
  v_mfma_f32_32x32x16_bf16 v[48:63], v[100:103], v[128:131], 0
  ds_read_b64_tr_b16 v[96:97], v10 offset:512
  ds_read_b64_tr_b16 v[98:99], v10 offset:768
  s_add_u32 m0, s50, 50176
  v_xor_b32 v10, 88064, v8
  buffer_load_dwordx4 v7, s[4:7], s87 offen lds
  v_mfma_f32_16x16x32_bf16 v[76:79], v[28:31], v[100:103], 0
  s_waitcnt lgkmcnt(9)
  v_mfma_f32_32x32x16_bf16 v[32:47], v[104:107], v[132:135], v[32:47]
  ds_read_b64_tr_b16 v[100:101], v10 offset:0
  ds_read_b64_tr_b16 v[102:103], v10 offset:256
  s_add_u32 m0, s49, 114688
  s_nop 0
  buffer_load_dwordx4 v2, s[8:11], s79 offen lds
  s_waitcnt lgkmcnt(9)
  v_mfma_f32_32x32x16_bf16 v[48:63], v[108:111], v[132:135], v[48:63]
  ds_read_b64_tr_b16 v[104:105], v10 offset:512
  ds_read_b64_tr_b16 v[106:107], v10 offset:768
  s_add_u32 m0, s49, 122880
  v_xor_b32 v10, 98304, v8
  buffer_load_dwordx4 v3, s[8:11], s79 offen lds
  buffer_load_dwordx2 v[90:91], off, s[36:39], s3 sc1
  s_waitcnt vmcnt(7) lgkmcnt(6)
  s_barrier
  v_mfma_f32_32x32x16_bf16 v[32:47], v[112:115], v[136:139], v[32:47]
  ds_read_b64_tr_b16 v[108:109], v10 offset:0
  ds_read_b64_tr_b16 v[110:111], v10 offset:256
  ds_read_b128 v[144:147], v84 offset:16384
  s_add_u32 m0, s50, 65536
  s_nop 0
  buffer_load_dwordx4 v6, s[4:7], s88 offen lds
  s_waitcnt lgkmcnt(7)
  v_mfma_f32_32x32x16_bf16 v[48:63], v[96:99], v[136:139], v[48:63]
  ds_read_b64_tr_b16 v[112:113], v10 offset:512
  ds_read_b64_tr_b16 v[114:115], v10 offset:768
  ds_read_b128 v[148:151], v85 offset:16384
  s_add_u32 m0, s50, 66560
  v_xor_b32 v10, 100352, v8
  buffer_load_dwordx4 v7, s[4:7], s88 offen lds
  s_waitcnt lgkmcnt(8)
  v_mfma_f32_32x32x16_bf16 v[32:47], v[100:103], v[140:143], v[32:47]
  ds_read_b64_tr_b16 v[96:97], v10 offset:0
  ds_read_b64_tr_b16 v[98:99], v10 offset:256
  ds_read_b128 v[152:155], v86 offset:16384
  s_add_u32 m0, s49, 131072
  s_nop 0
  buffer_load_dwordx4 v2, s[8:11], s80 offen lds
  s_waitcnt lgkmcnt(9)
  v_mfma_f32_32x32x16_bf16 v[48:63], v[104:107], v[140:143], v[48:63]
  ds_read_b64_tr_b16 v[100:101], v10 offset:512
  ds_read_b64_tr_b16 v[102:103], v10 offset:768
  ds_read_b128 v[156:159], v87 offset:16384
  s_add_u32 m0, s49, 139264
  v_xor_b32 v10, 102400, v8
  buffer_load_dwordx4 v3, s[8:11], s80 offen lds
  s_waitcnt lgkmcnt(9)
  v_mfma_f32_32x32x16_bf16 v[32:47], v[108:111], v[144:147], v[32:47]
  ds_read_b64_tr_b16 v[104:105], v10 offset:0
  ds_read_b64_tr_b16 v[106:107], v10 offset:256
  s_add_u32 m0, s50, 16384
  s_nop 0
  buffer_load_dwordx4 v6, s[4:7], s89 offen lds
  v_mfma_f32_16x16x32_bf16 v[72:75], v[28:31], v[108:111], v[72:75]
  s_waitcnt lgkmcnt(9)
  v_mfma_f32_32x32x16_bf16 v[48:63], v[112:115], v[144:147], v[48:63]
  ds_read_b64_tr_b16 v[108:109], v10 offset:512
  ds_read_b64_tr_b16 v[110:111], v10 offset:768
  s_add_u32 m0, s50, 17408
  v_xor_b32 v10, 104448, v8
  buffer_load_dwordx4 v7, s[4:7], s89 offen lds
  v_mfma_f32_16x16x32_bf16 v[76:79], v[28:31], v[112:115], v[76:79]
  s_waitcnt lgkmcnt(8)
  v_mfma_f32_32x32x16_bf16 v[32:47], v[96:99], v[148:151], v[32:47]
  ds_read_b64_tr_b16 v[112:113], v10 offset:0
  ds_read_b64_tr_b16 v[114:115], v10 offset:256
  s_add_u32 m0, s49, 147456
  s_nop 0
  buffer_load_dwordx4 v2, s[8:11], s81 offen lds
  s_waitcnt lgkmcnt(7)
  v_mfma_f32_32x32x16_bf16 v[48:63], v[100:103], v[148:151], v[48:63]
  ds_read_b64_tr_b16 v[96:97], v10 offset:512
  ds_read_b64_tr_b16 v[98:99], v10 offset:768
  s_add_u32 m0, s49, 155648
  v_xor_b32 v10, 114688, v8
  buffer_load_dwordx4 v3, s[8:11], s81 offen lds
  buffer_load_dwordx2 v[92:93], off, s[36:39], s3 sc1
  s_waitcnt vmcnt(10) lgkmcnt(8)
  s_or_b32 s51, s44, s67
  s_cmp_lg_u32 s51, 0
  s_cbranch_scc0 OSOK_2
SOK_2:
  s_barrier
  s_waitcnt lgkmcnt(6)
  v_mfma_f32_32x32x16_bf16 v[32:47], v[104:107], v[152:155], v[32:47]
  ds_read_b64_tr_b16 v[100:101], v10 offset:0
  ds_read_b64_tr_b16 v[102:103], v10 offset:256
  ds_read_b128 v[160:163], v84 offset:32768
  s_add_u32 m0, s50, 32768
  s_nop 0
  buffer_load_dwordx4 v6, s[4:7], s90 offen lds
  s_waitcnt lgkmcnt(7)
  v_mfma_f32_32x32x16_bf16 v[48:63], v[108:111], v[152:155], v[48:63]
  ds_read_b64_tr_b16 v[104:105], v10 offset:512
  ds_read_b64_tr_b16 v[106:107], v10 offset:768
  ds_read_b128 v[164:167], v85 offset:32768
  v_xor_b32 v10, 116736, v8
  s_waitcnt lgkmcnt(8)
  v_mfma_f32_32x32x16_bf16 v[32:47], v[112:115], v[156:159], v[32:47]
  ds_read_b64_tr_b16 v[108:109], v10 offset:0
  ds_read_b64_tr_b16 v[110:111], v10 offset:256
  ds_read_b128 v[168:171], v86 offset:32768
  s_add_u32 m0, s50, 33792
  s_nop 0
  buffer_load_dwordx4 v7, s[4:7], s90 offen lds
  s_waitcnt lgkmcnt(9)
  v_mfma_f32_32x32x16_bf16 v[48:63], v[96:99], v[156:159], v[48:63]
  ds_read_b64_tr_b16 v[112:113], v10 offset:512
  ds_read_b64_tr_b16 v[114:115], v10 offset:768
  ds_read_b128 v[172:175], v87 offset:32768
  v_xor_b32 v10, 118784, v8
  s_waitcnt lgkmcnt(9)
  v_mfma_f32_32x32x16_bf16 v[32:47], v[100:103], v[160:163], v[32:47]
  ds_read_b64_tr_b16 v[96:97], v10 offset:0
  ds_read_b64_tr_b16 v[98:99], v10 offset:256
  s_add_u32 m0, s49, 81920
  s_nop 0
  buffer_load_dwordx4 v2, s[8:11], s82 offen lds
  v_mfma_f32_16x16x32_bf16 v[72:75], v[28:31], v[100:103], v[72:75]
  s_waitcnt lgkmcnt(9)
  v_mfma_f32_32x32x16_bf16 v[48:63], v[104:107], v[160:163], v[48:63]
  ds_read_b64_tr_b16 v[100:101], v10 offset:512
  ds_read_b64_tr_b16 v[102:103], v10 offset:768
  v_xor_b32 v10, 120832, v8
  v_mfma_f32_16x16x32_bf16 v[76:79], v[28:31], v[104:107], v[76:79]
  s_waitcnt lgkmcnt(8)
  v_mfma_f32_32x32x16_bf16 v[32:47], v[108:111], v[164:167], v[32:47]
  ds_read_b64_tr_b16 v[104:105], v10 offset:0
  ds_read_b64_tr_b16 v[106:107], v10 offset:256
  s_add_u32 m0, s49, 90112
  s_nop 0
  buffer_load_dwordx4 v3, s[8:11], s82 offen lds
  s_waitcnt lgkmcnt(7)
  v_mfma_f32_32x32x16_bf16 v[48:63], v[112:115], v[164:167], v[48:63]
  ds_read_b64_tr_b16 v[108:109], v10 offset:512
  ds_read_b64_tr_b16 v[110:111], v10 offset:768
  v_xor_b32 v10, 131072, v8
  s_waitcnt vmcnt(9) lgkmcnt(8)
  s_or_b32 s51, s44, s67
  s_cmp_lg_u32 s51, 0
  s_cbranch_scc0 OSOK_5
SOK_5:
  s_barrier
  s_waitcnt lgkmcnt(6)
  v_mfma_f32_32x32x16_bf16 v[32:47], v[96:99], v[168:171], v[32:47]
  ds_read_b64_tr_b16 v[112:113], v10 offset:0
  ds_read_b64_tr_b16 v[114:115], v10 offset:256
  ds_read_b128 v[176:179], v84 offset:49152
  s_add_u32 m0, s50, 49152
  s_nop 0
  buffer_load_dwordx4 v6, s[4:7], s91 offen lds
  s_waitcnt lgkmcnt(7)
  v_mfma_f32_32x32x16_bf16 v[48:63], v[100:103], v[168:171], v[48:63]
  ds_read_b64_tr_b16 v[96:97], v10 offset:512
  ds_read_b64_tr_b16 v[98:99], v10 offset:768
  ds_read_b128 v[180:183], v85 offset:49152
  v_xor_b32 v10, 133120, v8
  s_waitcnt lgkmcnt(8)
  v_mfma_f32_32x32x16_bf16 v[32:47], v[104:107], v[172:175], v[32:47]
  ds_read_b64_tr_b16 v[100:101], v10 offset:0
  ds_read_b64_tr_b16 v[102:103], v10 offset:256
  ds_read_b128 v[184:187], v86 offset:49152
  s_add_u32 m0, s50, 50176
  s_nop 0
  buffer_load_dwordx4 v7, s[4:7], s91 offen lds
  s_waitcnt lgkmcnt(9)
  v_mfma_f32_32x32x16_bf16 v[48:63], v[108:111], v[172:175], v[48:63]
  ds_read_b64_tr_b16 v[104:105], v10 offset:512
  ds_read_b64_tr_b16 v[106:107], v10 offset:768
  ds_read_b128 v[188:191], v87 offset:49152
  v_xor_b32 v10, 135168, v8
  s_waitcnt lgkmcnt(9)
  v_mfma_f32_32x32x16_bf16 v[32:47], v[112:115], v[176:179], v[32:47]
  ds_read_b64_tr_b16 v[108:109], v10 offset:0
  ds_read_b64_tr_b16 v[110:111], v10 offset:256
  s_add_u32 m0, s49, 98304
  s_nop 0
  buffer_load_dwordx4 v2, s[8:11], s83 offen lds
  v_mfma_f32_16x16x32_bf16 v[72:75], v[28:31], v[112:115], v[72:75]
  s_waitcnt lgkmcnt(9)
  v_mfma_f32_32x32x16_bf16 v[48:63], v[96:99], v[176:179], v[48:63]
  ds_read_b64_tr_b16 v[112:113], v10 offset:512
  ds_read_b64_tr_b16 v[114:115], v10 offset:768
  v_xor_b32 v10, 137216, v8
  v_mfma_f32_16x16x32_bf16 v[76:79], v[28:31], v[96:99], v[76:79]
  s_waitcnt lgkmcnt(8)
  v_mfma_f32_32x32x16_bf16 v[32:47], v[100:103], v[180:183], v[32:47]
  ds_read_b64_tr_b16 v[96:97], v10 offset:0
  ds_read_b64_tr_b16 v[98:99], v10 offset:256
  s_add_u32 m0, s49, 106496
  s_nop 0
  buffer_load_dwordx4 v3, s[8:11], s83 offen lds
  s_waitcnt lgkmcnt(7)
  v_mfma_f32_32x32x16_bf16 v[48:63], v[104:107], v[180:183], v[48:63]
  ds_read_b64_tr_b16 v[100:101], v10 offset:512
  ds_read_b64_tr_b16 v[102:103], v10 offset:768
  v_xor_b32 v10, 147456, v8
  s_waitcnt vmcnt(9) lgkmcnt(8)
  s_or_b32 s51, s44, s67
  s_cmp_lg_u32 s51, 0
  s_cbranch_scc0 OSOK_8
SOK_8:
  s_barrier
  s_waitcnt lgkmcnt(6)
  v_mfma_f32_32x32x16_bf16 v[32:47], v[108:111], v[184:187], v[32:47]
  ds_read_b64_tr_b16 v[104:105], v10 offset:0
  ds_read_b64_tr_b16 v[106:107], v10 offset:256
  ds_read_b128 v[192:195], v84 offset:0
  s_lshl_b32 s97, s2, 3
  s_add_u32 s97, s97, s44
  s_mul_i32 s98, s97, 896
  v_min_u32 v124, 6, v0
  v_lshlrev_b32 v124, 7, v124
  s_add_u32 m0, s50, 65536
  s_nop 0
  buffer_load_dwordx4 v6, s[4:7], s92 offen lds
  s_waitcnt lgkmcnt(7)
  v_mfma_f32_32x32x16_bf16 v[48:63], v[112:115], v[184:187], v[48:63]
  ds_read_b64_tr_b16 v[108:109], v10 offset:512
  ds_read_b64_tr_b16 v[110:111], v10 offset:768
  ds_read_b128 v[196:199], v85 offset:0
  buffer_load_dword v125, v124, s[28:31], s98 offen
  s_lshl_b32 s98, s97, 8
  v_and_b32 v124, 128, v124
  buffer_load_dword v126, v124, s[16:19], s98 offen
  v_xor_b32 v10, 149504, v8
  s_waitcnt lgkmcnt(8)
  v_mfma_f32_32x32x16_bf16 v[32:47], v[96:99], v[188:191], v[32:47]
  ds_read_b64_tr_b16 v[112:113], v10 offset:0
  ds_read_b64_tr_b16 v[114:115], v10 offset:256
  ds_read_b128 v[200:203], v86 offset:0
  s_mul_i32 s85, s85, 1792
  s_mul_i32 s86, s86, 1792
  s_mul_i32 s87, s87, 1792
  s_mul_i32 s88, s88, 1792
  s_mul_i32 s89, s89, 1792
  s_mul_i32 s90, s90, 1792
  s_add_u32 m0, s50, 66560
  s_nop 0
  buffer_load_dwordx4 v7, s[4:7], s92 offen lds
  s_waitcnt lgkmcnt(9)
  v_mfma_f32_32x32x16_bf16 v[48:63], v[100:103], v[188:191], v[48:63]
  ds_read_b64_tr_b16 v[96:97], v10 offset:512
  ds_read_b64_tr_b16 v[98:99], v10 offset:768
  ds_read_b128 v[204:207], v87 offset:0
  s_mul_i32 s91, s91, 1792
  s_mul_i32 s92, s92, 1792
  v_xor_b32 v10, 151552, v8
  s_waitcnt lgkmcnt(9)
  v_mfma_f32_32x32x16_bf16 v[32:47], v[104:107], v[192:195], v[32:47]
  ds_read_b64_tr_b16 v[100:101], v10 offset:0
  ds_read_b64_tr_b16 v[102:103], v10 offset:256
  s_add_u32 m0, s49, 114688
  s_nop 0
  buffer_load_dwordx4 v2, s[8:11], s84 offen lds
  v_mfma_f32_16x16x32_bf16 v[72:75], v[28:31], v[104:107], v[72:75]
  s_waitcnt lgkmcnt(9)
  v_mfma_f32_32x32x16_bf16 v[48:63], v[108:111], v[192:195], v[48:63]
  ds_read_b64_tr_b16 v[104:105], v10 offset:512
  ds_read_b64_tr_b16 v[106:107], v10 offset:768
  v_xor_b32 v10, 153600, v8
  v_mfma_f32_16x16x32_bf16 v[76:79], v[28:31], v[108:111], v[76:79]
  s_waitcnt lgkmcnt(8)
  v_mfma_f32_32x32x16_bf16 v[32:47], v[112:115], v[196:199], v[32:47]
  ds_read_b64_tr_b16 v[108:109], v10 offset:0
  ds_read_b64_tr_b16 v[110:111], v10 offset:256
  v_bfe_u32 v122, v0, 2, 3
  v_mul_u32_u24 v122, 1024, v122
  v_lshrrev_b32 v123, 5, v0
  v_lshl_add_u32 v122, v123, 6, v122
  v_and_b32 v123, 3, v0
  s_add_u32 m0, s49, 122880
  s_nop 0
  buffer_load_dwordx4 v3, s[8:11], s84 offen lds
  s_waitcnt lgkmcnt(7)
  v_mfma_f32_32x32x16_bf16 v[48:63], v[96:99], v[196:199], v[48:63]
  ds_read_b64_tr_b16 v[112:113], v10 offset:512
  ds_read_b64_tr_b16 v[114:115], v10 offset:768
  v_lshl_add_u32 v122, v123, 4, v122
  v_add_u32 v6, s53, v122
  v_add_u32 v7, 8192, v6
  v_xor_b32 v10, 81920, v8
  s_waitcnt vmcnt(10) lgkmcnt(8)
  s_barrier
  s_waitcnt lgkmcnt(6)
  v_mfma_f32_32x32x16_bf16 v[32:47], v[100:103], v[200:203], v[32:47]
  ds_read_b64_tr_b16 v[96:97], v10 offset:0
  ds_read_b64_tr_b16 v[98:99], v10 offset:256
  ds_read_b128 v[208:211], v84 offset:16384
  s_lshl_b32 s97, s48, 6
  s_add_u32 s97, s97, 3072
  v_lshrrev_b32 v122, 2, v0
  v_mul_u32_u24 v122, 3584, v122
  v_and_b32 v123, 3, v0
  s_add_u32 m0, s49, 131072
  s_nop 0
  buffer_load_dwordx4 v4, s[20:23], s85 offen lds
  s_waitcnt lgkmcnt(7)
  v_mfma_f32_32x32x16_bf16 v[48:63], v[104:107], v[200:203], v[48:63]
  ds_read_b64_tr_b16 v[100:101], v10 offset:512
  ds_read_b64_tr_b16 v[102:103], v10 offset:768
  ds_read_b128 v[212:215], v85 offset:16384
  v_lshl_add_u32 v122, v123, 4, v122
  v_add_u32 v2, s97, v122
  v_xor_b32 v3, 32, v2
  s_lshr_b32 s97, s52, 2
  v_xor_b32 v10, 83968, v8
  s_waitcnt lgkmcnt(8)
  v_mfma_f32_32x32x16_bf16 v[32:47], v[108:111], v[204:207], v[32:47]
  ds_read_b64_tr_b16 v[104:105], v10 offset:0
  ds_read_b64_tr_b16 v[106:107], v10 offset:256
  ds_read_b128 v[216:219], v86 offset:16384
  s_add_u32 s97, s97, s52
  s_and_b32 s97, s97, 3
  s_lshl_b32 s83, s97, 17
  s_and_b32 s84, s83, 0x20000
  s_lshl_b32 s97, s97, 13
  s_xor_b32 s98, s97, 0
  s_add_u32 m0, s49, 139264
  s_nop 0
  buffer_load_dwordx4 v5, s[24:27], s85 offen lds
  s_waitcnt lgkmcnt(9)
  v_mfma_f32_32x32x16_bf16 v[48:63], v[112:115], v[204:207], v[48:63]
  ds_read_b64_tr_b16 v[108:109], v10 offset:512
  ds_read_b64_tr_b16 v[110:111], v10 offset:768
  ds_read_b128 v[220:223], v87 offset:16384
  s_add_u32 s77, s98, s62
  s_xor_b32 s98, s97, 8192
  s_add_u32 s78, s98, s62
  s_xor_b32 s98, s97, 16384
  s_add_u32 s79, s98, s62
  s_xor_b32 s98, s97, 24576
  v_xor_b32 v10, 86016, v8
  s_waitcnt lgkmcnt(9)
  v_mfma_f32_32x32x16_bf16 v[32:47], v[96:99], v[208:211], v[32:47]
  ds_read_b64_tr_b16 v[112:113], v10 offset:0
  ds_read_b64_tr_b16 v[114:115], v10 offset:256
  s_add_u32 s80, s98, s62
  s_and_b32 s97, s97, 0x2000
  s_xor_b32 s98, s97, 0
  s_add_u32 s81, s98, s62
  s_xor_b32 s98, s97, 8192
  s_add_u32 s82, s98, s62
  v_mfma_f32_16x16x32_bf16 v[72:75], v[28:31], v[96:99], v[72:75]
  s_waitcnt lgkmcnt(9)
  v_mfma_f32_32x32x16_bf16 v[48:63], v[100:103], v[208:211], v[48:63]
  ds_read_b64_tr_b16 v[96:97], v10 offset:512
  ds_read_b64_tr_b16 v[98:99], v10 offset:768
  v_and_b32 v70, 31, v0
  v_lshlrev_b32 v70, 4, v70
  s_lshl_b32 s74, s47, 2
  s_add_u32 s74, s74, s45
  s_lshl_b32 s74, s74, 9
  s_add_u32 s74, s74, 10003456
  v_xor_b32 v10, 88064, v8
  v_mfma_f32_16x16x32_bf16 v[76:79], v[28:31], v[100:103], v[76:79]
  s_waitcnt lgkmcnt(8)
  v_mfma_f32_32x32x16_bf16 v[32:47], v[104:107], v[212:215], v[32:47]
  ds_read_b64_tr_b16 v[100:101], v10 offset:0
  ds_read_b64_tr_b16 v[102:103], v10 offset:256
  buffer_load_dwordx4 v[64:67], v70, s[40:43], s74 offen sc1
  v_mov_b32 v68, 0
  ds_read_b64 v[68:69], v68 offset:4160
  s_waitcnt lgkmcnt(8)
  v_mfma_f32_32x32x16_bf16 v[48:63], v[108:111], v[212:215], v[48:63]
  ds_read_b64_tr_b16 v[104:105], v10 offset:512
  ds_read_b64_tr_b16 v[106:107], v10 offset:768
  v_xor_b32 v10, 98304, v8
  s_waitcnt vmcnt(9) lgkmcnt(9)
  s_barrier
  s_waitcnt lgkmcnt(7)
  v_mfma_f32_32x32x16_bf16 v[32:47], v[112:115], v[216:219], v[32:47]
  ds_read_b64_tr_b16 v[108:109], v10 offset:0
  ds_read_b64_tr_b16 v[110:111], v10 offset:256
  ds_read_b128 v[224:227], v84 offset:32768
  s_add_u32 m0, s49, 147456
  s_nop 0
  buffer_load_dwordx4 v4, s[20:23], s86 offen lds
  s_waitcnt lgkmcnt(8)
  v_mfma_f32_32x32x16_bf16 v[48:63], v[96:99], v[216:219], v[48:63]
  ds_read_b64_tr_b16 v[112:113], v10 offset:512
  ds_read_b64_tr_b16 v[114:115], v10 offset:768
  ds_read_b128 v[228:231], v85 offset:32768
  v_xor_b32 v10, 100352, v8
  s_waitcnt lgkmcnt(9)
  v_mfma_f32_32x32x16_bf16 v[32:47], v[100:103], v[220:223], v[32:47]
  ds_read_b64_tr_b16 v[96:97], v10 offset:0
  ds_read_b64_tr_b16 v[98:99], v10 offset:256
  ds_read_b128 v[232:235], v86 offset:32768
  s_add_u32 m0, s49, 155648
  s_nop 0
  buffer_load_dwordx4 v5, s[24:27], s86 offen lds
  s_waitcnt lgkmcnt(9)
  v_mfma_f32_32x32x16_bf16 v[48:63], v[104:107], v[220:223], v[48:63]
  ds_read_b64_tr_b16 v[100:101], v10 offset:512
  ds_read_b64_tr_b16 v[102:103], v10 offset:768
  ds_read_b128 v[236:239], v87 offset:32768
  v_xor_b32 v10, 102400, v8
  s_waitcnt lgkmcnt(9)
  v_mfma_f32_32x32x16_bf16 v[32:47], v[108:111], v[224:227], v[32:47]
  ds_read_b64_tr_b16 v[104:105], v10 offset:0
  ds_read_b64_tr_b16 v[106:107], v10 offset:256
  v_mfma_f32_16x16x32_bf16 v[72:75], v[28:31], v[108:111], v[72:75]
  s_waitcnt lgkmcnt(9)
  v_mfma_f32_32x32x16_bf16 v[48:63], v[112:115], v[224:227], v[48:63]
  ds_read_b64_tr_b16 v[108:109], v10 offset:512
  ds_read_b64_tr_b16 v[110:111], v10 offset:768
  v_xor_b32 v10, 104448, v8
  v_mfma_f32_16x16x32_bf16 v[76:79], v[28:31], v[112:115], v[76:79]
  s_waitcnt lgkmcnt(8)
  v_mfma_f32_32x32x16_bf16 v[32:47], v[96:99], v[228:231], v[32:47]
  ds_read_b64_tr_b16 v[112:113], v10 offset:0
  ds_read_b64_tr_b16 v[114:115], v10 offset:256
  s_waitcnt lgkmcnt(7)
  v_mfma_f32_32x32x16_bf16 v[48:63], v[100:103], v[228:231], v[48:63]
  ds_read_b64_tr_b16 v[96:97], v10 offset:512
  ds_read_b64_tr_b16 v[98:99], v10 offset:768
  v_xor_b32 v10, 114688, v8
  s_waitcnt vmcnt(5) lgkmcnt(8)
  s_barrier
  s_waitcnt lgkmcnt(6)
  v_mfma_f32_32x32x16_bf16 v[32:47], v[104:107], v[232:235], v[32:47]
  ds_read_b64_tr_b16 v[100:101], v10 offset:0
  ds_read_b64_tr_b16 v[102:103], v10 offset:256
  ds_read_b128 v[240:243], v84 offset:49152
  s_add_u32 m0, s49, 81920
  s_nop 0
  buffer_load_dwordx4 v4, s[20:23], s87 offen lds
  s_waitcnt lgkmcnt(7)
  v_mfma_f32_32x32x16_bf16 v[48:63], v[108:111], v[232:235], v[48:63]
  ds_read_b64_tr_b16 v[104:105], v10 offset:512
  ds_read_b64_tr_b16 v[106:107], v10 offset:768
  ds_read_b128 v[244:247], v85 offset:49152
  v_mov_b32 v24, -1
  v_mov_b32 v25, -1
  v_mov_b32 v26, -1
  v_mov_b32 v27, -1
  v_xor_b32 v10, 116736, v8
  s_waitcnt lgkmcnt(8)
  v_mfma_f32_32x32x16_bf16 v[32:47], v[112:115], v[236:239], v[32:47]
  ds_read_b64_tr_b16 v[108:109], v10 offset:0
  ds_read_b64_tr_b16 v[110:111], v10 offset:256
  ds_read_b128 v[248:251], v86 offset:49152
  v_and_b32 v23, 0x1f0, v1
  buffer_store_dwordx4 v[24:27], v23, s[40:43], s64 offen sc1
  v_and_b32 v23, 16, v1
  buffer_store_dwordx4 v[24:27], v23, s[40:43], s65 offen sc1
  s_add_u32 m0, s49, 90112
  s_nop 0
  buffer_load_dwordx4 v5, s[24:27], s87 offen lds
  s_waitcnt lgkmcnt(9)
  v_mfma_f32_32x32x16_bf16 v[48:63], v[96:99], v[236:239], v[48:63]
  ds_read_b64_tr_b16 v[112:113], v10 offset:512
  ds_read_b64_tr_b16 v[114:115], v10 offset:768
  ds_read_b128 v[252:255], v87 offset:49152
  s_waitcnt vmcnt(6)
  v_cmp_eq_u64 s[68:69], v[66:67], v[68:69]
  v_cmp_ne_u32 s[70:71], 0, v69
  s_nop 1
  s_and_b64 s[68:69], s[68:69], s[70:71]
  s_cmp_eq_u64 s[68:69], -1
  s_cbranch_scc0 OGOK_11
GOK_11:
  v_readfirstlane_b32 s54, v68
  v_readfirstlane_b32 s55, v69
  v_xor_b32 v10, 118784, v8
  s_waitcnt lgkmcnt(10)
  v_mfma_f32_16x16x32_bf16 v[72:75], v[28:31], v[100:103], v[72:75]
  s_waitcnt lgkmcnt(9)
  v_mfma_f32_32x32x16_bf16 v[32:47], v[100:103], v[240:243], v[32:47]
  ds_read_b64_tr_b16 v[96:97], v10 offset:0
  ds_read_b64_tr_b16 v[98:99], v10 offset:256
  v_cvt_pk_bf16_f32 v117, v64, 0
  v_sqrt_f32 v13, v65
  v_lshlrev_b32 v66, 16, v117
  s_waitcnt lgkmcnt(9)
  v_mfma_f32_16x16x32_bf16 v[76:79], v[28:31], v[104:107], v[76:79]
  v_mfma_f32_32x32x16_bf16 v[48:63], v[104:107], v[240:243], v[48:63]
  ds_read_b64_tr_b16 v[100:101], v10 offset:512
  ds_read_b64_tr_b16 v[102:103], v10 offset:768
  v_and_b32 v75, 31, v0
  v_lshl_add_u32 v75, v75, 5, s99
  v_cvt_pk_bf16_f32 v72, v74, v74
  v_and_b32 v73, 0xffff0000, v72
  v_sub_f32 v73, v74, v73
  v_xor_b32 v10, 120832, v8
  s_waitcnt lgkmcnt(8)
  v_mfma_f32_32x32x16_bf16 v[32:47], v[108:111], v[244:247], v[32:47]
  ds_read_b64_tr_b16 v[104:105], v10 offset:0
  ds_read_b64_tr_b16 v[106:107], v10 offset:256
  v_cvt_pk_bf16_f32 v73, v73, 0
  ds_write_b64 v75, v[72:73] offset:12288
  v_cvt_pk_bf16_f32 v76, v78, v78
  v_and_b32 v77, 0xffff0000, v76
  v_sub_f32 v77, v78, v77
  s_waitcnt lgkmcnt(8)
  v_mfma_f32_32x32x16_bf16 v[48:63], v[112:115], v[244:247], v[48:63]
  ds_read_b64_tr_b16 v[108:109], v10 offset:512
  ds_read_b64_tr_b16 v[110:111], v10 offset:768
  v_cvt_pk_bf16_f32 v77, v77, 0
  ds_write_b64 v75, v[76:77] offset:13312
  v_rsq_f32 v15, v65
  v_sub_f32 v66, v64, v66
  v_xor_b32 v10, 131072, v8
  s_waitcnt lgkmcnt(0)
  s_barrier
  v_mfma_f32_32x32x16_bf16 v[32:47], v[96:99], v[248:251], v[32:47]
  ds_read_b64_tr_b16 v[112:113], v10 offset:0
  ds_read_b64_tr_b16 v[114:115], v10 offset:256
  v_and_b32 v75, 31, v0
  v_lshrrev_b32 v74, 5, v0
  v_lshlrev_b32 v75, 5, v75
  v_lshl_add_u32 v75, v74, 4, v75
  s_lshl_b32 s58, s46, 11
  s_add_u32 m0, s49, 65536
  s_nop 0
  buffer_load_dwordx4 v4, s[20:23], s88 offen lds
  v_mfma_f32_32x32x16_bf16 v[48:63], v[100:103], v[248:251], v[48:63]
  ds_read_b64_tr_b16 v[96:97], v10 offset:512
  ds_read_b64_tr_b16 v[98:99], v10 offset:768
  v_add_u32 v75, s58, v75
  ds_read_b128 v[76:79], v75 offset:13312
  ds_read_b128 v[72:75], v75 offset:12288
  v_mov_b32 v119, v117
  v_cvt_pk_bf16_f32 v116, v64, v66
  s_add_u32 m0, s49, 73728
  v_xor_b32 v10, 133120, v8
  buffer_load_dwordx4 v5, s[24:27], s88 offen lds
  v_mfma_f32_32x32x16_bf16 v[32:47], v[104:107], v[252:255], v[32:47]
  ds_read_b64_tr_b16 v[100:101], v10 offset:0
  ds_read_b64_tr_b16 v[102:103], v10 offset:256
  v_mov_b32 v16, v15
  v_mul_f32 v14, 0xbfb8aa3b, v15
  v_mov_b32 v118, v116
  v_mul_f32 v15, 0x3fb8aa3b, v15
  s_add_u32 m0, s49, 98304
  s_nop 0
  buffer_load_dwordx4 v4, s[20:23], s89 offen lds
  v_mfma_f32_32x32x16_bf16 v[48:63], v[108:111], v[252:255], v[48:63]
  ds_read_b64_tr_b16 v[104:105], v10 offset:512
  ds_read_b64_tr_b16 v[106:107], v10 offset:768
  s_waitcnt lgkmcnt(4)
  v_mfma_f32_32x32x16_bf16 v[32:47], v[72:75], v[116:119], v[32:47]
  v_mfma_f32_32x32x16_bf16 v[48:63], v[76:79], v[116:119], v[48:63]
  s_add_u32 s51, s60, 32768
  buffer_store_dwordx4 v[24:27], v1, s[40:43], s51 offen sc1
  s_nop 8
  v_cvt_pk_bf16_f32 v32, v32, v33
  v_cvt_pk_bf16_f32 v33, v34, v35
  v_cvt_pk_bf16_f32 v34, v36, v37
  v_cvt_pk_bf16_f32 v35, v38, v39
  v_cvt_pk_bf16_f32 v36, v48, v49
  v_cvt_pk_bf16_f32 v37, v50, v51
  v_cvt_pk_bf16_f32 v38, v52, v53
  v_cvt_pk_bf16_f32 v39, v54, v55
  v_mul_f32 v40, v16, v40
  v_mul_f32 v41, v16, v41
  v_mul_f32 v42, v16, v42
  v_mul_f32 v43, v16, v43
  v_mul_f32 v44, v16, v44
  v_mul_f32 v45, v16, v45
  v_mul_f32 v46, v16, v46
  v_mul_f32 v47, v16, v47
  v_cvt_pk_bf16_f32 v40, v40, v41
  v_cvt_pk_bf16_f32 v41, v42, v43
  v_cvt_pk_bf16_f32 v42, v44, v45
  v_cvt_pk_bf16_f32 v43, v46, v47
  ds_read_b64_tr_b16 v[44:45], v17 offset:512
  ds_read_b64_tr_b16 v[46:47], v17 offset:768
  v_mul_f32 v56, v16, v56
  v_mul_f32 v57, v16, v57
  v_mul_f32 v58, v16, v58
  v_mul_f32 v59, v16, v59
  v_mul_f32 v60, v16, v60
  v_mul_f32 v61, v16, v61
  v_mul_f32 v62, v16, v62
  v_mul_f32 v63, v16, v63
  v_cvt_pk_bf16_f32 v56, v56, v57
  v_cvt_pk_bf16_f32 v57, v58, v59
  v_cvt_pk_bf16_f32 v58, v60, v61
  v_cvt_pk_bf16_f32 v59, v62, v63
  ds_write_b128 v20, v[40:43] offset:0
  ds_write_b128 v20, v[56:59] offset:8192
  s_waitcnt lgkmcnt(3)
  v_xor_b32 v44, v18, v44
  v_xor_b32 v45, v18, v45
  s_waitcnt lgkmcnt(2)
  v_xor_b32 v46, v18, v46
  v_xor_b32 v47, v18, v47
  s_nop 1
  v_mfma_f32_32x32x16_bf16 v[48:63], v[44:47], v[32:35], 0
  ds_read_b64_tr_b16 v[32:33], v17 offset:1536
  ds_read_b64_tr_b16 v[34:35], v17 offset:1792
  s_nop 9
  v_max3_f32 v40, v48, v49, v50
  v_max3_f32 v41, v51, v52, v53
  v_max3_f32 v40, v40, v54, v55
  v_max3_f32 v41, v41, v56, v57
  v_max3_f32 v40, v40, v58, v59
  v_max3_f32 v41, v41, v60, v61
  v_max3_f32 v40, v40, v62, v63
  v_max_f32 v40, v40, v41
  v_mul_f32 v40, v14, v40
  v_fma_f32 v48, v48, v15, v40
  v_fma_f32 v49, v49, v15, v40
  v_fma_f32 v50, v50, v15, v40
  v_fma_f32 v51, v51, v15, v40
  v_fma_f32 v52, v52, v15, v40
  v_fma_f32 v53, v53, v15, v40
  v_fma_f32 v54, v54, v15, v40
  v_fma_f32 v55, v55, v15, v40
  v_fma_f32 v56, v56, v15, v40
  v_fma_f32 v57, v57, v15, v40
  v_fma_f32 v58, v58, v15, v40
  v_fma_f32 v59, v59, v15, v40
  v_fma_f32 v60, v60, v15, v40
  v_fma_f32 v61, v61, v15, v40
  v_fma_f32 v62, v62, v15, v40
  v_fma_f32 v63, v63, v15, v40
  v_exp_f32 v48, v48
  v_exp_f32 v49, v49
  v_exp_f32 v50, v50
  v_exp_f32 v51, v51
  v_exp_f32 v52, v52
  v_exp_f32 v53, v53
  v_exp_f32 v54, v54
  v_exp_f32 v55, v55
  v_exp_f32 v56, v56
  v_exp_f32 v57, v57
  v_exp_f32 v58, v58
  v_exp_f32 v59, v59
  v_exp_f32 v60, v60
  v_exp_f32 v61, v61
  v_exp_f32 v62, v62
  v_exp_f32 v63, v63
  v_add_f32 v40, v48, v49
  v_add_f32 v41, v50, v51
  v_add_f32 v40, v40, v52
  v_add_f32 v41, v41, v53
  v_add_f32 v40, v40, v54
  v_add_f32 v41, v41, v55
  v_add_f32 v40, v40, v56
  v_add_f32 v41, v41, v57
  v_add_f32 v40, v40, v58
  v_add_f32 v41, v41, v59
  v_add_f32 v40, v40, v60
  v_add_f32 v41, v41, v61
  v_add_f32 v40, v40, v62
  v_add_f32 v41, v41, v63
  v_add_f32 v40, v40, v41
  v_rcp_f32 v40, v40
  s_nop 0
  v_mul_f32 v48, v40, v48
  v_mul_f32 v49, v40, v49
  v_mul_f32 v50, v40, v50
  v_mul_f32 v51, v40, v51
  v_mul_f32 v52, v40, v52
  v_mul_f32 v53, v40, v53
  v_mul_f32 v54, v40, v54
  v_mul_f32 v55, v40, v55
  v_mul_f32 v56, v40, v56
  v_mul_f32 v57, v40, v57
  v_mul_f32 v58, v40, v58
  v_mul_f32 v59, v40, v59
  v_mul_f32 v60, v40, v60
  v_mul_f32 v61, v40, v61
  v_mul_f32 v62, v40, v62
  v_mul_f32 v63, v40, v63
  s_waitcnt lgkmcnt(1)
  v_xor_b32 v32, v18, v32
  v_xor_b32 v33, v18, v33
  s_waitcnt lgkmcnt(0)
  v_xor_b32 v34, v18, v34
  v_xor_b32 v35, v18, v35
  v_cvt_pk_bf16_f32 v40, v48, v49
  v_cvt_pk_bf16_f32 v41, v50, v51
  v_cvt_pk_bf16_f32 v42, v52, v53
  v_cvt_pk_bf16_f32 v43, v54, v55
  v_cvt_pk_bf16_f32 v44, v56, v57
  v_cvt_pk_bf16_f32 v45, v58, v59
  v_cvt_pk_bf16_f32 v46, v60, v61
  v_cvt_pk_bf16_f32 v47, v62, v63
  v_mfma_f32_32x32x16_bf16 v[48:63], v[32:35], v[36:39], 0
  ds_write_b128 v19, v[40:43] offset:0
  ds_write_b128 v19, v[44:47] offset:16
  v_xor_b32 v10, 135168, v8
  v_mfma_f32_32x32x16_bf16 v[64:79], v[112:115], v[128:131], 0
  ds_read_b64_tr_b16 v[108:109], v10 offset:0
  ds_read_b64_tr_b16 v[110:111], v10 offset:256
  s_add_u32 m0, s49, 106496
  s_nop 0
  buffer_load_dwordx4 v5, s[24:27], s89 offen lds
  v_mfma_f32_16x16x32_bf16 v[120:123], v[28:31], v[112:115], 0
  v_mfma_f32_32x32x16_bf16 v[80:95], v[96:99], v[128:131], 0
  ds_read_b64_tr_b16 v[112:113], v10 offset:512
  ds_read_b64_tr_b16 v[114:115], v10 offset:768
  v_max3_f32 v40, v48, v49, v50
  v_max3_f32 v41, v51, v52, v53
  v_max3_f32 v40, v40, v54, v55
  v_max3_f32 v41, v41, v56, v57
  v_xor_b32 v10, 137216, v8
  v_mfma_f32_16x16x32_bf16 v[124:127], v[28:31], v[96:99], 0
  v_mfma_f32_32x32x16_bf16 v[64:79], v[100:103], v[132:135], v[64:79]
  ds_read_b64_tr_b16 v[96:97], v10 offset:0
  ds_read_b64_tr_b16 v[98:99], v10 offset:256
  v_max3_f32 v40, v40, v58, v59
  v_max3_f32 v41, v41, v60, v61
  v_max3_f32 v40, v40, v62, v63
  v_max_f32 v40, v40, v41
  v_mfma_f32_32x32x16_bf16 v[80:95], v[104:107], v[132:135], v[80:95]
  ds_read_b64_tr_b16 v[100:101], v10 offset:512
  ds_read_b64_tr_b16 v[102:103], v10 offset:768
  v_mul_f32 v40, v14, v40
  v_fma_f32 v48, v48, v15, v40
  v_fma_f32 v49, v49, v15, v40
  v_fma_f32 v50, v50, v15, v40
  v_xor_b32 v10, 147456, v8
  s_waitcnt vmcnt(9)
  s_barrier
  s_waitcnt lgkmcnt(6)
  v_mfma_f32_32x32x16_bf16 v[64:79], v[108:111], v[136:139], v[64:79]
  ds_read_b64_tr_b16 v[104:105], v10 offset:0
  ds_read_b64_tr_b16 v[106:107], v10 offset:256
  v_fma_f32 v51, v51, v15, v40
  v_fma_f32 v52, v52, v15, v40
  v_fma_f32 v53, v53, v15, v40
  v_fma_f32 v54, v54, v15, v40
  s_add_u32 m0, s49, 114688
  s_nop 0
  buffer_load_dwordx4 v4, s[20:23], s90 offen lds
  s_waitcnt lgkmcnt(6)
  v_mfma_f32_32x32x16_bf16 v[80:95], v[112:115], v[136:139], v[80:95]
  ds_read_b64_tr_b16 v[108:109], v10 offset:512
  ds_read_b64_tr_b16 v[110:111], v10 offset:768
  v_fma_f32 v55, v55, v15, v40
  v_fma_f32 v56, v56, v15, v40
  v_fma_f32 v57, v57, v15, v40
  v_fma_f32 v58, v58, v15, v40
  s_add_u32 m0, s49, 122880
  v_xor_b32 v10, 149504, v8
  buffer_load_dwordx4 v5, s[24:27], s90 offen lds
  s_waitcnt lgkmcnt(6)
  v_mfma_f32_32x32x16_bf16 v[64:79], v[96:99], v[140:143], v[64:79]
  ds_read_b64_tr_b16 v[112:113], v10 offset:0
  ds_read_b64_tr_b16 v[114:115], v10 offset:256
  v_fma_f32 v59, v59, v15, v40
  v_fma_f32 v60, v60, v15, v40
  v_fma_f32 v61, v61, v15, v40
  v_fma_f32 v62, v62, v15, v40
  s_waitcnt lgkmcnt(6)
  v_mfma_f32_32x32x16_bf16 v[80:95], v[100:103], v[140:143], v[80:95]
  ds_read_b64_tr_b16 v[96:97], v10 offset:512
  ds_read_b64_tr_b16 v[98:99], v10 offset:768
  v_fma_f32 v63, v63, v15, v40
  v_exp_f32 v48, v48
  v_exp_f32 v49, v49
  v_xor_b32 v10, 151552, v8
  s_waitcnt lgkmcnt(6)
  v_mfma_f32_32x32x16_bf16 v[64:79], v[104:107], v[144:147], v[64:79]
  ds_read_b64_tr_b16 v[100:101], v10 offset:0
  ds_read_b64_tr_b16 v[102:103], v10 offset:256
  v_exp_f32 v50, v50
  v_exp_f32 v51, v51
  v_mfma_f32_16x16x32_bf16 v[120:123], v[28:31], v[104:107], v[120:123]
  s_waitcnt lgkmcnt(6)
  v_mfma_f32_32x32x16_bf16 v[80:95], v[108:111], v[144:147], v[80:95]
  ds_read_b64_tr_b16 v[104:105], v10 offset:512
  ds_read_b64_tr_b16 v[106:107], v10 offset:768
  s_add_u32 s51, s60, 34816
  buffer_store_dwordx4 v[24:27], v1, s[40:43], s51 offen sc1
  v_exp_f32 v52, v52
  v_xor_b32 v10, 153600, v8
  v_mfma_f32_16x16x32_bf16 v[124:127], v[28:31], v[108:111], v[124:127]
  s_waitcnt lgkmcnt(6)
  v_mfma_f32_32x32x16_bf16 v[64:79], v[112:115], v[148:151], v[64:79]
  ds_read_b64_tr_b16 v[108:109], v10 offset:0
  ds_read_b64_tr_b16 v[110:111], v10 offset:256
  v_exp_f32 v53, v53
  v_exp_f32 v54, v54
  s_waitcnt lgkmcnt(6)
  v_mfma_f32_32x32x16_bf16 v[80:95], v[96:99], v[148:151], v[80:95]
  ds_read_b64_tr_b16 v[112:113], v10 offset:512
  ds_read_b64_tr_b16 v[114:115], v10 offset:768
  v_exp_f32 v55, v55
  v_exp_f32 v56, v56
  v_xor_b32 v10, 81920, v8
  s_waitcnt vmcnt(8)
  s_barrier
  s_waitcnt lgkmcnt(6)
  v_mfma_f32_32x32x16_bf16 v[64:79], v[100:103], v[152:155], v[64:79]
  ds_read_b64_tr_b16 v[96:97], v10 offset:0
  ds_read_b64_tr_b16 v[98:99], v10 offset:256
  v_exp_f32 v57, v57
  v_exp_f32 v58, v58
  s_add_u32 m0, s49, 131072
  s_nop 0
  buffer_load_dwordx4 v4, s[20:23], s91 offen lds
  s_waitcnt lgkmcnt(6)
  v_mfma_f32_32x32x16_bf16 v[80:95], v[104:107], v[152:155], v[80:95]
  ds_read_b64_tr_b16 v[100:101], v10 offset:512
  ds_read_b64_tr_b16 v[102:103], v10 offset:768
  v_exp_f32 v59, v59
  v_exp_f32 v60, v60
  s_add_u32 m0, s49, 139264
  v_xor_b32 v10, 83968, v8
  buffer_load_dwordx4 v5, s[24:27], s91 offen lds
  s_waitcnt lgkmcnt(6)
  v_mfma_f32_32x32x16_bf16 v[64:79], v[108:111], v[156:159], v[64:79]
  ds_read_b64_tr_b16 v[104:105], v10 offset:0
  ds_read_b64_tr_b16 v[106:107], v10 offset:256
  v_exp_f32 v61, v61
  v_exp_f32 v62, v62
  s_waitcnt lgkmcnt(6)
  v_mfma_f32_32x32x16_bf16 v[80:95], v[112:115], v[156:159], v[80:95]
  ds_read_b64_tr_b16 v[108:109], v10 offset:512
  ds_read_b64_tr_b16 v[110:111], v10 offset:768
  v_exp_f32 v63, v63
  v_add_f32 v40, v48, v49
  v_add_f32 v41, v50, v51
  v_add_f32 v40, v40, v52
  v_xor_b32 v10, 86016, v8
  s_waitcnt lgkmcnt(6)
  v_mfma_f32_32x32x16_bf16 v[64:79], v[96:99], v[160:163], v[64:79]
  ds_read_b64_tr_b16 v[112:113], v10 offset:0
  ds_read_b64_tr_b16 v[114:115], v10 offset:256
  v_add_f32 v41, v41, v53
  v_add_f32 v40, v40, v54
  v_add_f32 v41, v41, v55
  v_add_f32 v40, v40, v56
  v_add_f32 v41, v41, v57
  v_mfma_f32_16x16x32_bf16 v[120:123], v[28:31], v[96:99], v[120:123]
  s_waitcnt lgkmcnt(6)
  v_mfma_f32_32x32x16_bf16 v[80:95], v[100:103], v[160:163], v[80:95]
  ds_read_b64_tr_b16 v[96:97], v10 offset:512
  ds_read_b64_tr_b16 v[98:99], v10 offset:768
  v_add_f32 v40, v40, v58
  v_add_f32 v41, v41, v59
  v_add_f32 v40, v40, v60
  v_add_f32 v41, v41, v61
  v_add_f32 v40, v40, v62
  v_xor_b32 v10, 88064, v8
  v_mfma_f32_16x16x32_bf16 v[124:127], v[28:31], v[100:103], v[124:127]
  s_waitcnt lgkmcnt(6)
  v_mfma_f32_32x32x16_bf16 v[64:79], v[104:107], v[164:167], v[64:79]
  ds_read_b64_tr_b16 v[100:101], v10 offset:0
  ds_read_b64_tr_b16 v[102:103], v10 offset:256
  v_add_f32 v41, v41, v63
  v_add_f32 v40, v40, v41
  v_rcp_f32 v40, v40
  s_nop 0
  v_mul_f32 v48, v40, v48
  s_waitcnt lgkmcnt(6)
  v_mfma_f32_32x32x16_bf16 v[80:95], v[108:111], v[164:167], v[80:95]
  ds_read_b64_tr_b16 v[104:105], v10 offset:512
  ds_read_b64_tr_b16 v[106:107], v10 offset:768
  s_add_u32 s51, s61, 98304
  buffer_store_dwordx4 v[24:27], v1, s[40:43], s51 offen sc1
  v_mul_f32 v49, v40, v49
  v_mul_f32 v50, v40, v50
  v_mul_f32 v51, v40, v51
  v_xor_b32 v10, 65536, v8
  s_waitcnt vmcnt(9)
  s_barrier
  s_waitcnt lgkmcnt(6)
  v_mfma_f32_32x32x16_bf16 v[64:79], v[112:115], v[168:171], v[64:79]
  ds_read_b64_tr_b16 v[108:109], v10 offset:0
  ds_read_b64_tr_b16 v[110:111], v10 offset:256
  v_mul_f32 v52, v40, v52
  v_mul_f32 v53, v40, v53
  v_mul_f32 v54, v40, v54
  v_mul_f32 v55, v40, v55
  v_mul_f32 v56, v40, v56
  s_add_u32 m0, s49, 147456
  s_nop 0
  buffer_load_dwordx4 v4, s[20:23], s92 offen lds
  s_waitcnt lgkmcnt(6)
  v_mfma_f32_32x32x16_bf16 v[80:95], v[96:99], v[168:171], v[80:95]
  ds_read_b64_tr_b16 v[112:113], v10 offset:512
  ds_read_b64_tr_b16 v[114:115], v10 offset:768
  v_mul_f32 v57, v40, v57
  v_mul_f32 v58, v40, v58
  v_mul_f32 v59, v40, v59
  v_mul_f32 v60, v40, v60
  v_mul_f32 v61, v40, v61
  s_add_u32 m0, s49, 155648
  v_xor_b32 v10, 67584, v8
  buffer_load_dwordx4 v5, s[24:27], s92 offen lds
  s_waitcnt lgkmcnt(6)
  v_mfma_f32_32x32x16_bf16 v[64:79], v[100:103], v[172:175], v[64:79]
  ds_read_b64_tr_b16 v[96:97], v10 offset:0
  ds_read_b64_tr_b16 v[98:99], v10 offset:256
  v_mul_f32 v62, v40, v62
  v_mul_f32 v63, v40, v63
  v_cvt_pk_bf16_f32 v48, v48, v49
  v_cvt_pk_bf16_f32 v49, v50, v51
  v_cvt_pk_bf16_f32 v50, v52, v53
  s_waitcnt lgkmcnt(6)
  v_mfma_f32_32x32x16_bf16 v[80:95], v[104:107], v[172:175], v[80:95]
  ds_read_b64_tr_b16 v[100:101], v10 offset:512
  ds_read_b64_tr_b16 v[102:103], v10 offset:768
  v_cvt_pk_bf16_f32 v51, v54, v55
  v_cvt_pk_bf16_f32 v52, v56, v57
  v_cvt_pk_bf16_f32 v53, v58, v59
  v_cvt_pk_bf16_f32 v54, v60, v61
  v_xor_b32 v10, 69632, v8
  s_waitcnt lgkmcnt(6)
  v_mfma_f32_32x32x16_bf16 v[64:79], v[108:111], v[176:179], v[64:79]
  ds_read_b64_tr_b16 v[104:105], v10 offset:0
  ds_read_b64_tr_b16 v[106:107], v10 offset:256
  v_cvt_pk_bf16_f32 v55, v62, v63
  ds_write_b128 v19, v[48:51] offset:16384
  ds_write_b128 v19, v[52:55] offset:16400
  v_lshrrev_b32 v35, 2, v0
  v_and_b32 v36, 3, v0
  v_mfma_f32_16x16x32_bf16 v[120:123], v[28:31], v[108:111], v[120:123]
  s_waitcnt lgkmcnt(8)
  v_mfma_f32_32x32x16_bf16 v[80:95], v[112:115], v[176:179], v[80:95]
  ds_read_b64_tr_b16 v[108:109], v10 offset:512
  ds_read_b64_tr_b16 v[110:111], v10 offset:768
  v_lshlrev_b32 v36, 3, v36
  v_lshl_add_u32 v32, v35, 5, v36
  s_lshr_b32 s74, s44, 1
  s_lshl_b32 s75, s74, 12
  s_add_u32 s75, s75, 49152
  v_xor_b32 v10, 71680, v8
  v_mfma_f32_16x16x32_bf16 v[124:127], v[28:31], v[112:115], v[124:127]
  s_waitcnt lgkmcnt(8)
  v_mfma_f32_32x32x16_bf16 v[64:79], v[96:99], v[180:183], v[64:79]
  ds_read_b64_tr_b16 v[112:113], v10 offset:0
  ds_read_b64_tr_b16 v[114:115], v10 offset:256
  v_add_u32 v32, s75, v32
  v_lshl_add_u32 v33, v35, 6, v36
  v_bfe_u32 v35, v0, 4, 1
  s_and_b32 s75, s44, 1
  s_waitcnt lgkmcnt(8)
  v_mfma_f32_32x32x16_bf16 v[80:95], v[100:103], v[180:183], v[80:95]
  ds_read_b64_tr_b16 v[96:97], v10 offset:512
  ds_read_b64_tr_b16 v[98:99], v10 offset:768
  v_xor_b32 v36, s75, v35
  v_lshl_add_u32 v33, v36, 5, v33
  s_lshl_b32 s75, s74, 13
  s_add_u32 s75, s75, 16384
  v_add_u32 v33, s75, v33
  v_xor_b32 v10, 98304, v8
  s_waitcnt vmcnt(8) lgkmcnt(6)
  s_barrier
  v_mfma_f32_32x32x16_bf16 v[64:79], v[104:107], v[184:187], v[64:79]
  ds_read_b64_tr_b16 v[100:101], v10 offset:0
  ds_read_b64_tr_b16 v[102:103], v10 offset:256
  v_lshrrev_b32 v35, 4, v0
  v_lshlrev_b32 v35, 3, v35
  v_and_b32 v36, 3, v0
  v_lshl_add_u32 v34, v36, 5, v35
  v_and_b32 v36, 4, v0
  s_add_u32 m0, s49, 81920
  s_nop 0
  buffer_load_dwordx4 v2, s[20:23], s93 offen lds
  s_waitcnt lgkmcnt(6)
  v_mfma_f32_32x32x16_bf16 v[80:95], v[108:111], v[184:187], v[80:95]
  ds_read_b64_tr_b16 v[104:105], v10 offset:512
  ds_read_b64_tr_b16 v[106:107], v10 offset:768
  v_lshl_add_u32 v34, v36, 6, v34
  v_and_b32 v36, 8, v0
  v_lshl_add_u32 v34, v36, 4, v34
  v_mov_b32 v36, 0x3f803f80
  v_xor_b32 v10, 100352, v8
  s_waitcnt lgkmcnt(6)
  v_mfma_f32_32x32x16_bf16 v[64:79], v[112:115], v[188:191], v[64:79]
  ds_read_b64_tr_b16 v[108:109], v10 offset:0
  ds_read_b64_tr_b16 v[110:111], v10 offset:256
  v_mov_b32 v37, 0x3f803f80
  v_mov_b32 v38, 0x3f803f80
  v_mov_b32 v39, 0x3f803f80
  ds_read_b64_tr_b16 v[48:49], v32 offset:0
  ds_read_b64_tr_b16 v[50:51], v32 offset:512
  s_add_u32 m0, s49, 90112
  s_nop 0
  buffer_load_dwordx4 v3, s[24:27], s93 offen lds
  s_waitcnt lgkmcnt(8)
  v_mfma_f32_32x32x16_bf16 v[80:95], v[96:99], v[188:191], v[80:95]
  ds_read_b64_tr_b16 v[112:113], v10 offset:512
  ds_read_b64_tr_b16 v[114:115], v10 offset:768
  ds_read_b64_tr_b16 v[52:53], v33 offset:0
  ds_read_b64_tr_b16 v[54:55], v33 offset:1024
  ds_read_b64_tr_b16 v[56:57], v32 offset:1024
  ds_read_b64_tr_b16 v[58:59], v32 offset:1536
  ds_read_b64_tr_b16 v[60:61], v33 offset:2048
  v_xor_b32 v10, 102400, v8
  s_waitcnt lgkmcnt(13)
  v_mfma_f32_32x32x16_bf16 v[64:79], v[100:103], v[192:195], v[64:79]
  ds_read_b64_tr_b16 v[96:97], v10 offset:0
  ds_read_b64_tr_b16 v[98:99], v10 offset:256
  ds_read_b64_tr_b16 v[62:63], v33 offset:3072
  v_mfma_f32_16x16x32_bf16 v[120:123], v[28:31], v[100:103], v[120:123]
  s_waitcnt lgkmcnt(14)
  v_mfma_f32_32x32x16_bf16 v[80:95], v[104:107], v[192:195], v[80:95]
  ds_read_b64_tr_b16 v[100:101], v10 offset:512
  ds_read_b64_tr_b16 v[102:103], v10 offset:768
  v_xor_b32 v10, 104448, v8
  v_mfma_f32_16x16x32_bf16 v[124:127], v[28:31], v[104:107], v[124:127]
  s_waitcnt lgkmcnt(14)
  v_mfma_f32_32x32x16_bf16 v[64:79], v[108:111], v[196:199], v[64:79]
  ds_read_b64_tr_b16 v[104:105], v10 offset:0
  ds_read_b64_tr_b16 v[106:107], v10 offset:256
  s_waitcnt lgkmcnt(12)
  v_mfma_f32_32x32x16_bf16 v[80:95], v[112:115], v[196:199], v[80:95]
  ds_read_b64_tr_b16 v[108:109], v10 offset:512
  ds_read_b64_tr_b16 v[110:111], v10 offset:768
  s_waitcnt lgkmcnt(12)
  v_mfma_f32_16x16x32_bf16 v[40:43], v[52:55], v[48:51], 0
  v_mfma_f32_16x16x32_bf16 v[44:47], v[52:55], v[36:39], 0
  ds_read_b64_tr_b16 v[48:49], v32 offset:2048
  ds_read_b64_tr_b16 v[50:51], v32 offset:2560
  ds_read_b64_tr_b16 v[52:53], v33 offset:4096
  ds_read_b64_tr_b16 v[54:55], v33 offset:5120
  s_waitcnt lgkmcnt(10)
  v_mfma_f32_16x16x32_bf16 v[40:43], v[60:63], v[56:59], v[40:43]
  v_mfma_f32_16x16x32_bf16 v[44:47], v[60:63], v[36:39], v[44:47]
  ds_read_b64_tr_b16 v[56:57], v32 offset:3072
  v_xor_b32 v10, 114688, v8
  s_waitcnt vmcnt(4)
  s_barrier
  s_cmp_lg_u32 s44, 0
  s_cbranch_scc0 OPUB_15
PUB_15:
  s_cmp_lg_u32 s44, 0
  s_cbranch_scc0 OPUB_16
PUB_16:
  v_mfma_f32_32x32x16_bf16 v[64:79], v[96:99], v[200:203], v[64:79]
  ds_read_b64_tr_b16 v[112:113], v10 offset:0
  ds_read_b64_tr_b16 v[114:115], v10 offset:256
  ds_read_b64_tr_b16 v[58:59], v32 offset:3584
  ds_read_b64_tr_b16 v[60:61], v33 offset:6144
  ds_read_b64_tr_b16 v[62:63], v33 offset:7168
  s_add_u32 m0, s49, 65536
  s_nop 0
  buffer_load_dwordx4 v2, s[20:23], s94 offen lds
  s_waitcnt lgkmcnt(14)
  v_mfma_f32_32x32x16_bf16 v[80:95], v[100:103], v[200:203], v[80:95]
  ds_read_b64_tr_b16 v[96:97], v10 offset:512
  ds_read_b64_tr_b16 v[98:99], v10 offset:768
  v_xor_b32 v10, 116736, v8
  s_waitcnt lgkmcnt(14)
  v_mfma_f32_32x32x16_bf16 v[64:79], v[104:107], v[204:207], v[64:79]
  ds_read_b64_tr_b16 v[100:101], v10 offset:0
  ds_read_b64_tr_b16 v[102:103], v10 offset:256
  s_add_u32 m0, s49, 73728
  s_nop 0
  buffer_load_dwordx4 v3, s[24:27], s94 offen lds
  s_waitcnt lgkmcnt(14)
  v_mfma_f32_32x32x16_bf16 v[80:95], v[108:111], v[204:207], v[80:95]
  ds_read_b64_tr_b16 v[104:105], v10 offset:512
  ds_read_b64_tr_b16 v[106:107], v10 offset:768
  s_waitcnt lgkmcnt(12)
  v_mfma_f32_16x16x32_bf16 v[40:43], v[52:55], v[48:51], v[40:43]
  v_mfma_f32_16x16x32_bf16 v[44:47], v[52:55], v[36:39], v[44:47]
  s_waitcnt lgkmcnt(6)
  v_mfma_f32_16x16x32_bf16 v[40:43], v[60:63], v[56:59], v[40:43]
  v_mfma_f32_16x16x32_bf16 v[44:47], v[60:63], v[36:39], v[44:47]
  v_xor_b32 v10, 118784, v8
  v_mfma_f32_32x32x16_bf16 v[64:79], v[112:115], v[208:211], v[64:79]
  ds_read_b64_tr_b16 v[108:109], v10 offset:0
  ds_read_b64_tr_b16 v[110:111], v10 offset:256
  v_mfma_f32_16x16x32_bf16 v[120:123], v[28:31], v[112:115], v[120:123]
  s_waitcnt lgkmcnt(6)
  v_mfma_f32_32x32x16_bf16 v[80:95], v[96:99], v[208:211], v[80:95]
  ds_read_b64_tr_b16 v[112:113], v10 offset:512
  ds_read_b64_tr_b16 v[114:115], v10 offset:768
  v_cvt_pk_bf16_f32 v40, v40, v41
  v_cvt_pk_bf16_f32 v41, v42, v43
  buffer_store_dwordx2 v[40:41], v34, s[40:43], s64 offen sc1
  v_cvt_pk_bf16_f32 v44, v44, v45
  v_cvt_pk_bf16_f32 v45, v46, v47
  v_xor_b32 v10, 120832, v8
  v_mfma_f32_16x16x32_bf16 v[124:127], v[28:31], v[96:99], v[124:127]
  s_waitcnt lgkmcnt(6)
  v_mfma_f32_32x32x16_bf16 v[64:79], v[100:103], v[212:215], v[64:79]
  ds_read_b64_tr_b16 v[96:97], v10 offset:0
  ds_read_b64_tr_b16 v[98:99], v10 offset:256
  buffer_store_dwordx2 v[44:45], v35, s[40:43], s65 offen sc1
  s_waitcnt lgkmcnt(6)
  v_mfma_f32_32x32x16_bf16 v[80:95], v[104:107], v[212:215], v[80:95]
  ds_read_b64_tr_b16 v[100:101], v10 offset:512
  ds_read_b64_tr_b16 v[102:103], v10 offset:768
  v_xor_b32 v10, 131072, v8
  s_barrier
  s_waitcnt lgkmcnt(6)
  v_mfma_f32_32x32x16_bf16 v[64:79], v[108:111], v[216:219], v[64:79]
  ds_read_b64_tr_b16 v[104:105], v10 offset:0
  ds_read_b64_tr_b16 v[106:107], v10 offset:256
  s_add_u32 m0, s49, 16384
  s_nop 0
  buffer_load_dwordx4 v2, s[20:23], s95 offen lds
  s_waitcnt lgkmcnt(6)
  v_mfma_f32_32x32x16_bf16 v[80:95], v[112:115], v[216:219], v[80:95]
  ds_read_b64_tr_b16 v[108:109], v10 offset:512
  ds_read_b64_tr_b16 v[110:111], v10 offset:768
  v_xor_b32 v10, 133120, v8
  s_waitcnt lgkmcnt(6)
  v_mfma_f32_32x32x16_bf16 v[64:79], v[96:99], v[220:223], v[64:79]
  ds_read_b64_tr_b16 v[112:113], v10 offset:0
  ds_read_b64_tr_b16 v[114:115], v10 offset:256
  s_add_u32 m0, s49, 24576
  s_nop 0
  buffer_load_dwordx4 v3, s[24:27], s95 offen lds
  s_waitcnt lgkmcnt(6)
  v_mfma_f32_32x32x16_bf16 v[80:95], v[100:103], v[220:223], v[80:95]
  ds_read_b64_tr_b16 v[96:97], v10 offset:512
  ds_read_b64_tr_b16 v[98:99], v10 offset:768
  v_xor_b32 v10, 135168, v8
  s_waitcnt lgkmcnt(6)
  v_mfma_f32_32x32x16_bf16 v[64:79], v[104:107], v[224:227], v[64:79]
  ds_read_b64_tr_b16 v[100:101], v10 offset:0
  ds_read_b64_tr_b16 v[102:103], v10 offset:256
  v_mfma_f32_16x16x32_bf16 v[120:123], v[28:31], v[104:107], v[120:123]
  s_waitcnt lgkmcnt(6)
  v_mfma_f32_32x32x16_bf16 v[80:95], v[108:111], v[224:227], v[80:95]
  ds_read_b64_tr_b16 v[104:105], v10 offset:512
  ds_read_b64_tr_b16 v[106:107], v10 offset:768
  v_xor_b32 v10, 137216, v8
  v_mfma_f32_16x16x32_bf16 v[124:127], v[28:31], v[108:111], v[124:127]
  s_waitcnt lgkmcnt(6)
  v_mfma_f32_32x32x16_bf16 v[64:79], v[112:115], v[228:231], v[64:79]
  ds_read_b64_tr_b16 v[108:109], v10 offset:0
  ds_read_b64_tr_b16 v[110:111], v10 offset:256
  s_add_u32 m0, s49, 32768
  s_nop 0
  buffer_load_dwordx4 v2, s[20:23], s96 offen lds
  s_waitcnt lgkmcnt(6)
  v_mfma_f32_32x32x16_bf16 v[80:95], v[96:99], v[228:231], v[80:95]
  ds_read_b64_tr_b16 v[112:113], v10 offset:512
  ds_read_b64_tr_b16 v[114:115], v10 offset:768
  v_xor_b32 v10, 147456, v8
  s_waitcnt vmcnt(9)
  s_barrier
  s_waitcnt lgkmcnt(6)
  v_mfma_f32_32x32x16_bf16 v[64:79], v[100:103], v[232:235], v[64:79]
  ds_read_b64_tr_b16 v[96:97], v10 offset:0
  ds_read_b64_tr_b16 v[98:99], v10 offset:256
  s_waitcnt lgkmcnt(6)
  v_mfma_f32_32x32x16_bf16 v[80:95], v[104:107], v[232:235], v[80:95]
  ds_read_b64_tr_b16 v[100:101], v10 offset:512
  ds_read_b64_tr_b16 v[102:103], v10 offset:768
  v_xor_b32 v10, 149504, v8
  s_waitcnt lgkmcnt(6)
  v_mfma_f32_32x32x16_bf16 v[64:79], v[108:111], v[236:239], v[64:79]
  ds_read_b64_tr_b16 v[104:105], v10 offset:0
  ds_read_b64_tr_b16 v[106:107], v10 offset:256
  s_add_u32 m0, s49, 40960
  s_nop 0
  buffer_load_dwordx4 v3, s[24:27], s96 offen lds
  s_waitcnt lgkmcnt(6)
  v_mfma_f32_32x32x16_bf16 v[80:95], v[112:115], v[236:239], v[80:95]
  ds_read_b64_tr_b16 v[108:109], v10 offset:512
  ds_read_b64_tr_b16 v[110:111], v10 offset:768
  v_min_u32 v23, 15, v0
  s_add_u32 s97, s76, 9994624
  v_lshl_add_u32 v23, v23, 3, s97
  buffer_load_dwordx2 v[24:25], v23, s[40:43], s3 offen sc1
  v_xor_b32 v10, 151552, v8
  s_waitcnt lgkmcnt(6)
  v_mfma_f32_16x16x32_bf16 v[120:123], v[28:31], v[96:99], v[120:123]
  v_mfma_f32_32x32x16_bf16 v[64:79], v[96:99], v[240:243], v[64:79]
  ds_read_b64_tr_b16 v[112:113], v10 offset:0
  ds_read_b64_tr_b16 v[114:115], v10 offset:256
  s_waitcnt lgkmcnt(6)
  v_mfma_f32_16x16x32_bf16 v[124:127], v[28:31], v[100:103], v[124:127]
  v_mfma_f32_32x32x16_bf16 v[80:95], v[100:103], v[240:243], v[80:95]
  ds_read_b64_tr_b16 v[96:97], v10 offset:512
  ds_read_b64_tr_b16 v[98:99], v10 offset:768
  v_and_b32 v123, 31, v0
  v_lshl_add_u32 v123, v123, 5, s99
  v_cvt_pk_bf16_f32 v120, v122, v122
  v_and_b32 v121, 0xffff0000, v120
  v_xor_b32 v10, 153600, v8
  s_waitcnt lgkmcnt(6)
  v_mfma_f32_32x32x16_bf16 v[64:79], v[104:107], v[244:247], v[64:79]
  ds_read_b64_tr_b16 v[100:101], v10 offset:0
  ds_read_b64_tr_b16 v[102:103], v10 offset:256
  v_sub_f32 v121, v122, v121
  v_cvt_pk_bf16_f32 v121, v121, 0
  ds_write_b64 v123, v[120:121] offset:12288
  v_cvt_pk_bf16_f32 v124, v126, v126
  v_and_b32 v125, 0xffff0000, v124
  s_add_u32 m0, s50, 49152
  s_xor_b32 s72, s83, 0
  buffer_load_dwordx4 v6, s[28:31], s72 offen lds
  s_waitcnt lgkmcnt(7)
  v_mfma_f32_32x32x16_bf16 v[80:95], v[108:111], v[244:247], v[80:95]
  ds_read_b64_tr_b16 v[104:105], v10 offset:512
  ds_read_b64_tr_b16 v[106:107], v10 offset:768
  v_sub_f32 v125, v126, v125
  v_cvt_pk_bf16_f32 v125, v125, 0
  ds_write_b64 v123, v[124:125] offset:13312
  v_xor_b32 v10, 81920, v9
  s_waitcnt vmcnt(10) lgkmcnt(0)
  s_barrier
  v_mfma_f32_32x32x16_bf16 v[64:79], v[112:115], v[248:251], v[64:79]
  ds_read_b64_tr_b16 v[108:109], v10 offset:0
  ds_read_b64_tr_b16 v[110:111], v10 offset:256
  v_and_b32 v123, 31, v0
  v_lshrrev_b32 v122, 5, v0
  v_lshlrev_b32 v123, 5, v123
  v_lshl_add_u32 v123, v122, 4, v123
  s_lshl_b32 s58, s46, 11
  s_add_u32 m0, s50, 50176
  s_nop 0
  buffer_load_dwordx4 v7, s[28:31], s72 offen lds
  v_mfma_f32_32x32x16_bf16 v[80:95], v[96:99], v[248:251], v[80:95]
  ds_read_b64_tr_b16 v[112:113], v10 offset:4096
  ds_read_b64_tr_b16 v[114:115], v10 offset:4352
  v_add_u32 v123, s58, v123
  ds_read_b128 v[124:127], v123 offset:13312
  ds_read_b128 v[120:123], v123 offset:12288
  s_add_u32 m0, s50, 98304
  s_xor_b32 s72, s83, 131072
  v_xor_b32 v10, 82944, v9
  buffer_load_dwordx4 v6, s[28:31], s72 offen lds
  v_mfma_f32_32x32x16_bf16 v[64:79], v[100:103], v[252:255], v[64:79]
  ds_read_b64_tr_b16 v[96:97], v10 offset:0
  ds_read_b64_tr_b16 v[98:99], v10 offset:256
  s_add_u32 m0, s50, 99328
  s_nop 0
  buffer_load_dwordx4 v7, s[28:31], s72 offen lds
  v_mfma_f32_32x32x16_bf16 v[80:95], v[104:107], v[252:255], v[80:95]
  ds_read_b64_tr_b16 v[100:101], v10 offset:4096
  ds_read_b64_tr_b16 v[102:103], v10 offset:4352
  s_waitcnt lgkmcnt(4)
  v_mfma_f32_32x32x16_bf16 v[64:79], v[120:123], v[116:119], v[64:79]
  v_mfma_f32_32x32x16_bf16 v[80:95], v[124:127], v[116:119], v[80:95]
  s_nop 10
  v_mul_f32 v64, v14, v64
  v_mul_f32 v65, v14, v65
  v_mul_f32 v66, v14, v66
  v_mul_f32 v67, v14, v67
  v_mul_f32 v68, v14, v68
  v_mul_f32 v69, v14, v69
  v_mul_f32 v70, v14, v70
  v_mul_f32 v71, v14, v71
  v_exp_f32 v64, v64
  v_exp_f32 v65, v65
  v_exp_f32 v66, v66
  v_exp_f32 v67, v67
  v_exp_f32 v68, v68
  v_exp_f32 v69, v69
  s_add_u32 m0, s50, 114688
  s_xor_b32 s72, s83, 262144
  buffer_load_dwordx4 v6, s[28:31], s72 offen lds
  v_exp_f32 v70, v70
  v_exp_f32 v71, v71
  v_fma_f32 v64, v64, v13, v13
  v_fma_f32 v65, v65, v13, v13
  v_fma_f32 v66, v66, v13, v13
  v_fma_f32 v67, v67, v13, v13
  v_fma_f32 v68, v68, v13, v13
  v_fma_f32 v69, v69, v13, v13
  v_fma_f32 v70, v70, v13, v13
  v_fma_f32 v71, v71, v13, v13
  v_rcp_f32 v64, v64
  v_rcp_f32 v65, v65
  v_rcp_f32 v66, v66
  s_add_u32 m0, s50, 115712
  s_nop 0
  buffer_load_dwordx4 v7, s[28:31], s72 offen lds
  v_rcp_f32 v67, v67
  v_rcp_f32 v68, v68
  v_rcp_f32 v69, v69
  v_rcp_f32 v70, v70
  v_rcp_f32 v71, v71
  v_mul_f32 v64, v64, v72
  v_mul_f32 v65, v65, v73
  v_mul_f32 v66, v66, v74
  v_mul_f32 v67, v67, v75
  v_mul_f32 v68, v68, v76
  v_mul_f32 v69, v69, v77
  v_mul_f32 v70, v70, v78
  v_mul_f32 v71, v71, v79
  v_cvt_pk_bf16_f32 v72, v64, v65
  v_cvt_pk_bf16_f32 v73, v66, v67
  s_add_u32 m0, s50, 131072
  s_xor_b32 s72, s83, 393216
  buffer_load_dwordx4 v6, s[28:31], s72 offen lds
  v_cvt_pk_bf16_f32 v74, v68, v69
  v_cvt_pk_bf16_f32 v75, v70, v71
  s_add_u32 s74, s60, 32768
  buffer_store_dwordx4 v[72:75], v1, s[40:43], s74 offen sc1
  v_mul_f32 v80, v14, v80
  v_mul_f32 v81, v14, v81
  v_mul_f32 v82, v14, v82
  v_mul_f32 v83, v14, v83
  v_mul_f32 v84, v14, v84
  v_mul_f32 v85, v14, v85
  v_mul_f32 v86, v14, v86
  v_mul_f32 v87, v14, v87
  v_exp_f32 v80, v80
  v_exp_f32 v81, v81
  v_exp_f32 v82, v82
  v_exp_f32 v83, v83
  s_add_u32 m0, s50, 132096
  s_nop 0
  buffer_load_dwordx4 v7, s[28:31], s72 offen lds
  v_exp_f32 v84, v84
  v_exp_f32 v85, v85
  v_exp_f32 v86, v86
  v_exp_f32 v87, v87
  v_fma_f32 v80, v80, v13, v13
  v_fma_f32 v81, v81, v13, v13
  v_fma_f32 v82, v82, v13, v13
  v_fma_f32 v83, v83, v13, v13
  v_fma_f32 v84, v84, v13, v13
  v_fma_f32 v85, v85, v13, v13
  v_fma_f32 v86, v86, v13, v13
  v_fma_f32 v87, v87, v13, v13
  v_rcp_f32 v80, v80
  v_rcp_f32 v81, v81
  v_rcp_f32 v82, v82
  v_rcp_f32 v83, v83
  v_rcp_f32 v84, v84
  v_rcp_f32 v85, v85
  v_rcp_f32 v86, v86
  v_rcp_f32 v87, v87
  v_mul_f32 v80, v80, v88
  v_mul_f32 v81, v81, v89
  v_mul_f32 v82, v82, v90
  v_mul_f32 v83, v83, v91
  v_mul_f32 v84, v84, v92
  v_mul_f32 v85, v85, v93
  v_mul_f32 v86, v86, v94
  v_mul_f32 v87, v87, v95
  v_cvt_pk_bf16_f32 v88, v80, v81
  v_cvt_pk_bf16_f32 v89, v82, v83
  v_cvt_pk_bf16_f32 v90, v84, v85
  v_cvt_pk_bf16_f32 v91, v86, v87
  s_add_u32 s74, s60, 34816
  buffer_store_dwordx4 v[88:91], v1, s[40:43], s74 offen sc1
  v_xor_b32 v10, 83968, v9
  v_mfma_f32_32x32x16_bf16 v[32:47], v[108:111], v[128:131], 0
  ds_read_b64_tr_b16 v[104:105], v10 offset:0
  ds_read_b64_tr_b16 v[106:107], v10 offset:256
  v_mfma_f32_16x16x32_bf16 v[120:123], v[28:31], v[108:111], 0
  v_mfma_f32_32x32x16_bf16 v[32:47], v[112:115], v[144:147], v[32:47]
  ds_read_b64_tr_b16 v[108:109], v10 offset:4096
  ds_read_b64_tr_b16 v[110:111], v10 offset:4352
  v_xor_b32 v10, 84992, v9
  v_mfma_f32_16x16x32_bf16 v[120:123], v[28:31], v[112:115], v[120:123]
  s_waitcnt lgkmcnt(6)
  v_mfma_f32_32x32x16_bf16 v[32:47], v[96:99], v[132:135], v[32:47]
  ds_read_b64_tr_b16 v[112:113], v10 offset:0
  ds_read_b64_tr_b16 v[114:115], v10 offset:256
  s_waitcnt lgkmcnt(6)
  v_mfma_f32_32x32x16_bf16 v[32:47], v[100:103], v[148:151], v[32:47]
  ds_read_b64_tr_b16 v[96:97], v10 offset:4096
  ds_read_b64_tr_b16 v[98:99], v10 offset:4352
  v_xor_b32 v10, 65536, v9
  s_waitcnt vmcnt(17)
  s_cmp_lg_u32 s44, 0
  s_cbranch_scc0 OPOK_13
POK_13:
  s_barrier
  s_waitcnt lgkmcnt(6)
  v_mfma_f32_32x32x16_bf16 v[32:47], v[104:107], v[136:139], v[32:47]
  ds_read_b64_tr_b16 v[100:101], v10 offset:0
  ds_read_b64_tr_b16 v[102:103], v10 offset:256
  s_add_u32 s97, s77, 0
  buffer_load_dwordx4 v[128:131], v1, s[40:43], s97 offen offset:0 sc1
  s_add_u32 m0, s50, 147456
  s_xor_b32 s72, s83, 524288
  buffer_load_dwordx4 v6, s[28:31], s72 offen lds
  s_waitcnt lgkmcnt(6)
  v_mfma_f32_32x32x16_bf16 v[32:47], v[108:111], v[152:155], v[32:47]
  ds_read_b64_tr_b16 v[104:105], v10 offset:4096
  ds_read_b64_tr_b16 v[106:107], v10 offset:4352
  v_xor_b32 v10, 66560, v9
  s_waitcnt lgkmcnt(6)
  v_mfma_f32_32x32x16_bf16 v[32:47], v[112:115], v[140:143], v[32:47]
  ds_read_b64_tr_b16 v[108:109], v10 offset:0
  ds_read_b64_tr_b16 v[110:111], v10 offset:256
  s_add_u32 s97, s79, 0
  buffer_load_dwordx4 v[144:147], v1, s[40:43], s97 offen offset:0 sc1
  s_waitcnt lgkmcnt(6)
  v_mfma_f32_32x32x16_bf16 v[32:47], v[96:99], v[156:159], v[32:47]
  ds_read_b64_tr_b16 v[112:113], v10 offset:4096
  ds_read_b64_tr_b16 v[114:115], v10 offset:4352
  v_xor_b32 v10, 67584, v9
  s_waitcnt lgkmcnt(6)
  v_mfma_f32_32x32x16_bf16 v[32:47], v[100:103], v[160:163], v[32:47]
  ds_read_b64_tr_b16 v[96:97], v10 offset:0
  ds_read_b64_tr_b16 v[98:99], v10 offset:256
  s_add_u32 s97, s77, 0
  buffer_load_dwordx4 v[132:135], v1, s[40:43], s97 offen offset:1024 sc1
  v_mfma_f32_16x16x32_bf16 v[120:123], v[28:31], v[100:103], v[120:123]
  s_waitcnt lgkmcnt(6)
  v_mfma_f32_32x32x16_bf16 v[32:47], v[104:107], v[176:179], v[32:47]
  ds_read_b64_tr_b16 v[100:101], v10 offset:4096
  ds_read_b64_tr_b16 v[102:103], v10 offset:4352
  v_xor_b32 v10, 68608, v9
  v_mfma_f32_16x16x32_bf16 v[120:123], v[28:31], v[104:107], v[120:123]
  s_waitcnt lgkmcnt(6)
  v_mfma_f32_32x32x16_bf16 v[32:47], v[108:111], v[164:167], v[32:47]
  ds_read_b64_tr_b16 v[104:105], v10 offset:0
  ds_read_b64_tr_b16 v[106:107], v10 offset:256
  s_add_u32 s97, s79, 0
  buffer_load_dwordx4 v[148:151], v1, s[40:43], s97 offen offset:1024 sc1
  s_add_u32 s97, s78, 0
  buffer_load_dwordx4 v[136:139], v1, s[40:43], s97 offen offset:0 sc1
  s_waitcnt lgkmcnt(6)
  v_mfma_f32_32x32x16_bf16 v[32:47], v[112:115], v[180:183], v[32:47]
  ds_read_b64_tr_b16 v[108:109], v10 offset:4096
  ds_read_b64_tr_b16 v[110:111], v10 offset:4352
  v_xor_b32 v10, 16384, v9
  s_waitcnt vmcnt(19)
  s_barrier
  s_waitcnt lgkmcnt(6)
  v_mfma_f32_32x32x16_bf16 v[32:47], v[96:99], v[168:171], v[32:47]
  ds_read_b64_tr_b16 v[112:113], v10 offset:0
  ds_read_b64_tr_b16 v[114:115], v10 offset:256
  s_add_u32 s97, s80, 0
  buffer_load_dwordx4 v[152:155], v1, s[40:43], s97 offen offset:0 sc1
  s_waitcnt lgkmcnt(6)
  v_mfma_f32_32x32x16_bf16 v[32:47], v[100:103], v[184:187], v[32:47]
  ds_read_b64_tr_b16 v[96:97], v10 offset:4096
  ds_read_b64_tr_b16 v[98:99], v10 offset:4352
  v_xor_b32 v10, 17408, v9
  s_waitcnt lgkmcnt(6)
  v_mfma_f32_32x32x16_bf16 v[32:47], v[104:107], v[172:175], v[32:47]
  ds_read_b64_tr_b16 v[100:101], v10 offset:0
  ds_read_b64_tr_b16 v[102:103], v10 offset:256
  s_add_u32 s97, s78, 0
  buffer_load_dwordx4 v[140:143], v1, s[40:43], s97 offen offset:1024 sc1
  s_waitcnt lgkmcnt(6)
  v_mfma_f32_32x32x16_bf16 v[32:47], v[108:111], v[188:191], v[32:47]
  ds_read_b64_tr_b16 v[104:105], v10 offset:4096
  ds_read_b64_tr_b16 v[106:107], v10 offset:4352
  v_xor_b32 v10, 18432, v9
  s_waitcnt lgkmcnt(6)
  v_mfma_f32_32x32x16_bf16 v[32:47], v[112:115], v[192:195], v[32:47]
  ds_read_b64_tr_b16 v[108:109], v10 offset:0
  ds_read_b64_tr_b16 v[110:111], v10 offset:256
  s_add_u32 s97, s80, 0
  buffer_load_dwordx4 v[156:159], v1, s[40:43], s97 offen offset:1024 sc1
  v_mfma_f32_16x16x32_bf16 v[120:123], v[28:31], v[112:115], v[120:123]
  s_waitcnt lgkmcnt(6)
  v_mfma_f32_32x32x16_bf16 v[32:47], v[96:99], v[208:211], v[32:47]
  ds_read_b64_tr_b16 v[112:113], v10 offset:4096
  ds_read_b64_tr_b16 v[114:115], v10 offset:4352
  s_add_u32 m0, s50, 148480
  v_xor_b32 v10, 19456, v9
  buffer_load_dwordx4 v7, s[28:31], s72 offen lds
  v_mfma_f32_16x16x32_bf16 v[120:123], v[28:31], v[96:99], v[120:123]
  s_waitcnt lgkmcnt(6)
  v_mfma_f32_32x32x16_bf16 v[32:47], v[100:103], v[196:199], v[32:47]
  ds_read_b64_tr_b16 v[96:97], v10 offset:0
  ds_read_b64_tr_b16 v[98:99], v10 offset:256
  s_add_u32 s97, s77, 32768
  buffer_load_dwordx4 v[160:163], v1, s[40:43], s97 offen offset:0 sc1
  s_waitcnt lgkmcnt(6)
  v_mfma_f32_32x32x16_bf16 v[32:47], v[104:107], v[212:215], v[32:47]
  ds_read_b64_tr_b16 v[100:101], v10 offset:4096
  ds_read_b64_tr_b16 v[102:103], v10 offset:4352
  v_xor_b32 v10, 32768, v9
  s_waitcnt vmcnt(22)
  s_barrier
  s_waitcnt lgkmcnt(6)
  v_mfma_f32_32x32x16_bf16 v[32:47], v[108:111], v[200:203], v[32:47]
  ds_read_b64_tr_b16 v[104:105], v10 offset:0
  ds_read_b64_tr_b16 v[106:107], v10 offset:256
  s_add_u32 s97, s77, 32768
  buffer_load_dwordx4 v[164:167], v1, s[40:43], s97 offen offset:1024 sc1
  s_waitcnt lgkmcnt(6)
  v_mfma_f32_32x32x16_bf16 v[32:47], v[112:115], v[216:219], v[32:47]
  ds_read_b64_tr_b16 v[108:109], v10 offset:4096
  ds_read_b64_tr_b16 v[110:111], v10 offset:4352
  v_xor_b32 v10, 33792, v9
  s_waitcnt lgkmcnt(6)
  v_mfma_f32_32x32x16_bf16 v[32:47], v[96:99], v[204:207], v[32:47]
  ds_read_b64_tr_b16 v[112:113], v10 offset:0
  ds_read_b64_tr_b16 v[114:115], v10 offset:256
  s_add_u32 s97, s78, 32768
  buffer_load_dwordx4 v[168:171], v1, s[40:43], s97 offen offset:0 sc1
  s_add_u32 s97, s78, 32768
  buffer_load_dwordx4 v[172:175], v1, s[40:43], s97 offen offset:1024 sc1
  s_waitcnt lgkmcnt(6)
  v_mfma_f32_32x32x16_bf16 v[32:47], v[100:103], v[220:223], v[32:47]
  ds_read_b64_tr_b16 v[96:97], v10 offset:4096
  ds_read_b64_tr_b16 v[98:99], v10 offset:4352
  v_xor_b32 v10, 34816, v9
  s_waitcnt lgkmcnt(6)
  v_mfma_f32_16x16x32_bf16 v[120:123], v[28:31], v[104:107], v[120:123]
  v_mfma_f32_32x32x16_bf16 v[32:47], v[104:107], v[224:227], v[32:47]
  ds_read_b64_tr_b16 v[100:101], v10 offset:0
  ds_read_b64_tr_b16 v[102:103], v10 offset:256
  s_add_u32 s97, s79, 32768
  buffer_load_dwordx4 v[176:179], v1, s[40:43], s97 offen offset:0 sc1
  s_waitcnt lgkmcnt(6)
  v_mfma_f32_16x16x32_bf16 v[120:123], v[28:31], v[108:111], v[120:123]
  v_mfma_f32_32x32x16_bf16 v[32:47], v[108:111], v[240:243], v[32:47]
  ds_read_b64_tr_b16 v[104:105], v10 offset:4096
  ds_read_b64_tr_b16 v[106:107], v10 offset:4352
  s_nop 4
  v_and_b32 v123, 31, v0
  v_lshl_add_u32 v123, v123, 5, s99
  v_cvt_pk_bf16_f32 v120, v122, v122
  v_and_b32 v121, 0xffff0000, v120
  v_sub_f32 v121, v122, v121
  v_cvt_pk_bf16_f32 v121, v121, 0
  ds_write_b64 v123, v[120:121] offset:12288
  v_xor_b32 v10, 35840, v9
  s_waitcnt lgkmcnt(7)
  v_mfma_f32_32x32x16_bf16 v[32:47], v[112:115], v[228:231], v[32:47]
  ds_read_b64_tr_b16 v[108:109], v10 offset:0
  ds_read_b64_tr_b16 v[110:111], v10 offset:256
  s_add_u32 s97, s79, 32768
  buffer_load_dwordx4 v[180:183], v1, s[40:43], s97 offen offset:1024 sc1
  s_waitcnt lgkmcnt(7)
  v_mfma_f32_32x32x16_bf16 v[32:47], v[96:99], v[244:247], v[32:47]
  ds_read_b64_tr_b16 v[112:113], v10 offset:4096
  ds_read_b64_tr_b16 v[114:115], v10 offset:4352
  v_xor_b32 v10, 49152, v11
  s_waitcnt vmcnt(24) lgkmcnt(4)
  s_barrier
  v_mfma_f32_32x32x16_bf16 v[32:47], v[100:103], v[232:235], v[32:47]
  ds_read_b64_tr_b16 v[96:97], v10 offset:0
  ds_read_b64_tr_b16 v[98:99], v10 offset:1024
  v_and_b32 v123, 31, v0
  v_lshrrev_b32 v122, 5, v0
  v_lshlrev_b32 v123, 5, v123
  v_lshl_add_u32 v123, v122, 4, v123
  s_lshl_b32 s58, s46, 11
  v_add_u32 v123, s58, v123
  ds_read_b128 v[120:123], v123 offset:12288
  s_add_u32 s97, s80, 32768
  buffer_load_dwordx4 v[184:187], v1, s[40:43], s97 offen offset:0 sc1
  s_add_u32 s97, s80, 32768
  buffer_load_dwordx4 v[188:191], v1, s[40:43], s97 offen offset:1024 sc1
  v_mfma_f32_32x32x16_bf16 v[32:47], v[104:107], v[248:251], v[32:47]
  ds_read_b64_tr_b16 v[100:101], v10 offset:512
  ds_read_b64_tr_b16 v[102:103], v10 offset:1536
  s_waitcnt lgkmcnt(7)
  v_mfma_f32_32x32x16_bf16 v[32:47], v[108:111], v[236:239], v[32:47]
  ds_read_b64_tr_b16 v[104:105], v10 offset:2048
  ds_read_b64_tr_b16 v[106:107], v10 offset:3072
  s_add_u32 m0, s50, 81920
  s_xor_b32 s72, s83, 655360
  buffer_load_dwordx4 v6, s[28:31], s72 offen lds
  s_waitcnt lgkmcnt(7)
  v_mfma_f32_32x32x16_bf16 v[32:47], v[112:115], v[252:255], v[32:47]
  ds_read_b64_tr_b16 v[108:109], v10 offset:2560
  ds_read_b64_tr_b16 v[110:111], v10 offset:3584
  s_waitcnt lgkmcnt(6)
  v_mfma_f32_32x32x16_bf16 v[32:47], v[120:123], v[116:119], v[32:47]
  s_nop 11
  v_mul_f32 v32, v14, v32
  v_mul_f32 v33, v14, v33
  v_mul_f32 v34, v14, v34
  v_mul_f32 v35, v14, v35
  v_mul_f32 v36, v14, v36
  v_mul_f32 v37, v14, v37
  v_mul_f32 v38, v14, v38
  v_mul_f32 v39, v14, v39
  v_exp_f32 v32, v32
  v_exp_f32 v33, v33
  s_add_u32 m0, s50, 82944
  s_nop 0
  buffer_load_dwordx4 v7, s[28:31], s72 offen lds
  v_exp_f32 v34, v34
  v_exp_f32 v35, v35
  v_exp_f32 v36, v36
  v_exp_f32 v37, v37
  v_exp_f32 v38, v38
  v_exp_f32 v39, v39
  v_fma_f32 v32, v32, v13, v13
  v_fma_f32 v33, v33, v13, v13
  v_fma_f32 v34, v34, v13, v13
  v_fma_f32 v35, v35, v13, v13
  v_fma_f32 v36, v36, v13, v13
  v_fma_f32 v37, v37, v13, v13
  s_add_u32 m0, s50, 65536
  s_xor_b32 s72, s83, 786432
  buffer_load_dwordx4 v6, s[28:31], s72 offen lds
  v_fma_f32 v38, v38, v13, v13
  v_fma_f32 v39, v39, v13, v13
  v_rcp_f32 v32, v32
  v_rcp_f32 v33, v33
  v_rcp_f32 v34, v34
  v_rcp_f32 v35, v35
  v_rcp_f32 v36, v36
  v_rcp_f32 v37, v37
  v_rcp_f32 v38, v38
  v_rcp_f32 v39, v39
  v_mul_f32 v32, v32, v40
  v_mul_f32 v33, v33, v41
  s_add_u32 m0, s50, 66560
  s_nop 0
  buffer_load_dwordx4 v7, s[28:31], s72 offen lds
  v_mul_f32 v34, v34, v42
  v_mul_f32 v35, v35, v43
  v_mul_f32 v36, v36, v44
  v_mul_f32 v37, v37, v45
  v_mul_f32 v38, v38, v46
  v_mul_f32 v39, v39, v47
  v_cvt_pk_bf16_f32 v40, v32, v33
  v_cvt_pk_bf16_f32 v41, v34, v35
  v_cvt_pk_bf16_f32 v42, v36, v37
  v_cvt_pk_bf16_f32 v43, v38, v39
  s_add_u32 s74, s61, 98304
  buffer_store_dwordx4 v[40:43], v1, s[40:43], s74 offen sc1
  v_xor_b32 v10, 98304, v11
  s_waitcnt vmcnt(29)
  s_barrier
  s_waitcnt vmcnt(22)
  v_mfma_f32_32x32x16_bf16 v[64:79], v[96:99], v[128:131], 0
  ds_read_b64_tr_b16 v[112:113], v10 offset:0
  ds_read_b64_tr_b16 v[114:115], v10 offset:1024
  s_add_u32 m0, s50, 16384
  s_xor_b32 s72, s83, 917504
  buffer_load_dwordx4 v6, s[28:31], s72 offen lds
  s_waitcnt lgkmcnt(6)
  v_mfma_f32_32x32x16_bf16 v[80:95], v[100:103], v[128:131], 0
  ds_read_b64_tr_b16 v[96:97], v10 offset:512
  ds_read_b64_tr_b16 v[98:99], v10 offset:1536
  s_add_u32 m0, s50, 17408
  s_nop 0
  buffer_load_dwordx4 v7, s[28:31], s72 offen lds
  s_waitcnt vmcnt(21) lgkmcnt(6)
  v_mfma_f32_32x32x16_bf16 v[64:79], v[104:107], v[132:135], v[64:79]
  ds_read_b64_tr_b16 v[100:101], v10 offset:2048
  ds_read_b64_tr_b16 v[102:103], v10 offset:3072
  s_add_u32 m0, s50, 32768
  s_xor_b32 s72, s83, 1048576
  buffer_load_dwordx4 v6, s[28:31], s72 offen lds
  s_waitcnt lgkmcnt(6)
  v_mfma_f32_32x32x16_bf16 v[80:95], v[108:111], v[132:135], v[80:95]
  ds_read_b64_tr_b16 v[104:105], v10 offset:2560
  ds_read_b64_tr_b16 v[106:107], v10 offset:3584
  v_xor_b32 v10, 114688, v11
  s_barrier
  s_waitcnt vmcnt(20) lgkmcnt(6)
  v_mfma_f32_32x32x16_bf16 v[64:79], v[112:115], v[136:139], v[64:79]
  ds_read_b64_tr_b16 v[108:109], v10 offset:0
  ds_read_b64_tr_b16 v[110:111], v10 offset:1024
  s_add_u32 m0, s50, 33792
  s_nop 0
  buffer_load_dwordx4 v7, s[28:31], s72 offen lds
  s_waitcnt lgkmcnt(6)
  v_mfma_f32_32x32x16_bf16 v[80:95], v[96:99], v[136:139], v[80:95]
  ds_read_b64_tr_b16 v[112:113], v10 offset:512
  ds_read_b64_tr_b16 v[114:115], v10 offset:1536
  s_add_u32 m0, s50, 49152
  s_xor_b32 s72, s83, 1179648
  buffer_load_dwordx4 v6, s[28:31], s72 offen lds
  s_waitcnt vmcnt(20) lgkmcnt(6)
  v_mfma_f32_32x32x16_bf16 v[64:79], v[100:103], v[140:143], v[64:79]
  ds_read_b64_tr_b16 v[96:97], v10 offset:2048
  ds_read_b64_tr_b16 v[98:99], v10 offset:3072
  s_add_u32 m0, s50, 50176
  s_nop 0
  buffer_load_dwordx4 v7, s[28:31], s72 offen lds
  s_waitcnt lgkmcnt(6)
  v_mfma_f32_32x32x16_bf16 v[80:95], v[104:107], v[140:143], v[80:95]
  ds_read_b64_tr_b16 v[100:101], v10 offset:2560
  ds_read_b64_tr_b16 v[102:103], v10 offset:3584
  v_xor_b32 v10, 131072, v11
  s_barrier
  s_waitcnt lgkmcnt(6)
  v_mfma_f32_32x32x16_bf16 v[64:79], v[108:111], v[144:147], v[64:79]
  ds_read_b64_tr_b16 v[104:105], v10 offset:0
  ds_read_b64_tr_b16 v[106:107], v10 offset:1024
  s_add_u32 m0, s50, 98304
  s_xor_b32 s72, s83, 1310720
  buffer_load_dwordx4 v6, s[28:31], s72 offen lds
  s_waitcnt lgkmcnt(6)
  v_mfma_f32_32x32x16_bf16 v[80:95], v[112:115], v[144:147], v[80:95]
  ds_read_b64_tr_b16 v[108:109], v10 offset:512
  ds_read_b64_tr_b16 v[110:111], v10 offset:1536
  s_add_u32 m0, s50, 99328
  s_nop 0
  buffer_load_dwordx4 v7, s[28:31], s72 offen lds
  s_waitcnt lgkmcnt(6)
  v_mfma_f32_32x32x16_bf16 v[64:79], v[96:99], v[148:151], v[64:79]
  ds_read_b64_tr_b16 v[112:113], v10 offset:2048
  ds_read_b64_tr_b16 v[114:115], v10 offset:3072
  s_waitcnt lgkmcnt(6)
  v_mfma_f32_32x32x16_bf16 v[80:95], v[100:103], v[148:151], v[80:95]
  ds_read_b64_tr_b16 v[96:97], v10 offset:2560
  ds_read_b64_tr_b16 v[98:99], v10 offset:3584
  v_xor_b32 v10, 147456, v11
  s_waitcnt vmcnt(21)
  s_barrier
  s_waitcnt lgkmcnt(6)
  v_mfma_f32_32x32x16_bf16 v[64:79], v[104:107], v[152:155], v[64:79]
  ds_read_b64_tr_b16 v[100:101], v10 offset:0
  ds_read_b64_tr_b16 v[102:103], v10 offset:1024
  s_add_u32 m0, s50, 114688
  s_xor_b32 s72, s83, 1441792
  buffer_load_dwordx4 v6, s[28:31], s72 offen lds
  s_waitcnt lgkmcnt(6)
  v_mfma_f32_32x32x16_bf16 v[80:95], v[108:111], v[152:155], v[80:95]
  ds_read_b64_tr_b16 v[104:105], v10 offset:512
  ds_read_b64_tr_b16 v[106:107], v10 offset:1536
  s_add_u32 m0, s50, 115712
  s_nop 0
  buffer_load_dwordx4 v7, s[28:31], s72 offen lds
  s_waitcnt lgkmcnt(6)
  v_mfma_f32_32x32x16_bf16 v[64:79], v[112:115], v[156:159], v[64:79]
  ds_read_b64_tr_b16 v[108:109], v10 offset:2048
  ds_read_b64_tr_b16 v[110:111], v10 offset:3072
  s_add_u32 s97, s77, 65536
  buffer_load_dwordx4 v[192:195], v1, s[40:43], s97 offen offset:0 sc1
  s_add_u32 s97, s77, 65536
  buffer_load_dwordx4 v[196:199], v1, s[40:43], s97 offen offset:1024 sc1
  s_waitcnt lgkmcnt(6)
  v_mfma_f32_32x32x16_bf16 v[80:95], v[96:99], v[156:159], v[80:95]
  ds_read_b64_tr_b16 v[112:113], v10 offset:2560
  ds_read_b64_tr_b16 v[114:115], v10 offset:3584
  v_xor_b32 v10, 81920, v11
  s_waitcnt vmcnt(15)
  s_barrier
  v_max3_u32 v26, v160, v161, v162
  v_max3_u32 v26, v26, v163, v164
  v_max3_u32 v26, v26, v165, v166
  v_max_u32 v26, v26, v167
  v_cmp_eq_u32 vcc, -1, v26
  s_nop 3
  s_cbranch_vccnz OVOK_17
VOK_17:
  s_waitcnt lgkmcnt(6)
  v_mfma_f32_32x32x16_bf16 v[64:79], v[100:103], v[160:163], v[64:79]
  ds_read_b64_tr_b16 v[96:97], v10 offset:0
  ds_read_b64_tr_b16 v[98:99], v10 offset:1024
  s_add_u32 s97, s78, 65536
  buffer_load_dwordx4 v[200:203], v1, s[40:43], s97 offen offset:0 sc1
  s_waitcnt lgkmcnt(6)
  v_mfma_f32_32x32x16_bf16 v[80:95], v[104:107], v[160:163], v[80:95]
  ds_read_b64_tr_b16 v[100:101], v10 offset:512
  ds_read_b64_tr_b16 v[102:103], v10 offset:1536
  s_waitcnt lgkmcnt(6)
  v_mfma_f32_32x32x16_bf16 v[64:79], v[108:111], v[164:167], v[64:79]
  ds_read_b64_tr_b16 v[104:105], v10 offset:2048
  ds_read_b64_tr_b16 v[106:107], v10 offset:3072
  s_add_u32 s97, s78, 65536
  buffer_load_dwordx4 v[204:207], v1, s[40:43], s97 offen offset:1024 sc1
  s_add_u32 s97, s79, 65536
  buffer_load_dwordx4 v[208:211], v1, s[40:43], s97 offen offset:0 sc1
  s_waitcnt lgkmcnt(6)
  v_mfma_f32_32x32x16_bf16 v[80:95], v[112:115], v[164:167], v[80:95]
  ds_read_b64_tr_b16 v[108:109], v10 offset:2560
  ds_read_b64_tr_b16 v[110:111], v10 offset:3584
  v_xor_b32 v10, 65536, v11
  s_waitcnt vmcnt(16)
  s_barrier
  v_max3_u32 v26, v168, v169, v170
  v_max3_u32 v26, v26, v171, v172
  v_max3_u32 v26, v26, v173, v174
  v_max_u32 v26, v26, v175
  v_cmp_eq_u32 vcc, -1, v26
  s_nop 3
  s_cbranch_vccnz OVOK_19
VOK_19:
  s_waitcnt lgkmcnt(6)
  v_mfma_f32_32x32x16_bf16 v[64:79], v[96:99], v[168:171], v[64:79]
  ds_read_b64_tr_b16 v[112:113], v10 offset:0
  ds_read_b64_tr_b16 v[114:115], v10 offset:1024
  s_add_u32 m0, s50, 131072
  s_xor_b32 s72, s84, 1572864
  buffer_load_dwordx4 v6, s[28:31], s72 offen lds
  s_waitcnt lgkmcnt(6)
  v_mfma_f32_32x32x16_bf16 v[80:95], v[100:103], v[168:171], v[80:95]
  ds_read_b64_tr_b16 v[96:97], v10 offset:512
  ds_read_b64_tr_b16 v[98:99], v10 offset:1536
  s_waitcnt lgkmcnt(6)
  v_mfma_f32_32x32x16_bf16 v[64:79], v[104:107], v[172:175], v[64:79]
  ds_read_b64_tr_b16 v[100:101], v10 offset:2048
  ds_read_b64_tr_b16 v[102:103], v10 offset:3072
  s_add_u32 s97, s79, 65536
  buffer_load_dwordx4 v[212:215], v1, s[40:43], s97 offen offset:1024 sc1
  s_add_u32 m0, s50, 132096
  s_nop 0
  buffer_load_dwordx4 v7, s[28:31], s72 offen lds
  s_waitcnt lgkmcnt(6)
  v_mfma_f32_32x32x16_bf16 v[80:95], v[108:111], v[172:175], v[80:95]
  ds_read_b64_tr_b16 v[104:105], v10 offset:2560
  ds_read_b64_tr_b16 v[106:107], v10 offset:3584
  v_xor_b32 v10, 16384, v11
  s_waitcnt vmcnt(16)
  s_barrier
  v_max3_u32 v26, v176, v177, v178
  v_max3_u32 v26, v26, v179, v180
  v_max3_u32 v26, v26, v181, v182
  v_max_u32 v26, v26, v183
  v_cmp_eq_u32 vcc, -1, v26
  s_nop 3
  s_cbranch_vccnz OVOK_21
VOK_21:
  s_waitcnt lgkmcnt(6)
  v_mfma_f32_32x32x16_bf16 v[64:79], v[112:115], v[176:179], v[64:79]
  ds_read_b64_tr_b16 v[108:109], v10 offset:0
  ds_read_b64_tr_b16 v[110:111], v10 offset:1024
  s_add_u32 s97, s80, 65536
  buffer_load_dwordx4 v[216:219], v1, s[40:43], s97 offen offset:0 sc1
  s_add_u32 m0, s50, 147456
  s_xor_b32 s72, s84, 1703936
  buffer_load_dwordx4 v6, s[28:31], s72 offen lds
  s_waitcnt lgkmcnt(6)
  v_mfma_f32_32x32x16_bf16 v[80:95], v[96:99], v[176:179], v[80:95]
  ds_read_b64_tr_b16 v[112:113], v10 offset:512
  ds_read_b64_tr_b16 v[114:115], v10 offset:1536
  s_waitcnt lgkmcnt(6)
  v_mfma_f32_32x32x16_bf16 v[64:79], v[100:103], v[180:183], v[64:79]
  ds_read_b64_tr_b16 v[96:97], v10 offset:2048
  ds_read_b64_tr_b16 v[98:99], v10 offset:3072
  s_add_u32 m0, s50, 148480
  s_nop 0
  buffer_load_dwordx4 v7, s[28:31], s72 offen lds
  s_waitcnt lgkmcnt(6)
  v_mfma_f32_32x32x16_bf16 v[80:95], v[104:107], v[180:183], v[80:95]
  ds_read_b64_tr_b16 v[100:101], v10 offset:2560
  ds_read_b64_tr_b16 v[102:103], v10 offset:3584
  v_xor_b32 v10, 32768, v11
  s_waitcnt vmcnt(17)
  s_barrier
  v_max3_u32 v26, v184, v185, v186
  v_max3_u32 v26, v26, v187, v188
  v_max3_u32 v26, v26, v189, v190
  v_max_u32 v26, v26, v191
  v_cmp_eq_u32 vcc, -1, v26
  s_nop 3
  s_cbranch_vccnz OVOK_23
VOK_23:
  s_waitcnt lgkmcnt(6)
  v_mfma_f32_32x32x16_bf16 v[64:79], v[108:111], v[184:187], v[64:79]
  ds_read_b64_tr_b16 v[104:105], v10 offset:0
  ds_read_b64_tr_b16 v[106:107], v10 offset:1024
  s_add_u32 s97, s80, 65536
  buffer_load_dwordx4 v[220:223], v1, s[40:43], s97 offen offset:1024 sc1
  s_add_u32 s97, s81, 98304
  buffer_load_dwordx4 v[224:227], v1, s[40:43], s97 offen offset:0 sc1
  s_waitcnt lgkmcnt(6)
  v_mfma_f32_32x32x16_bf16 v[80:95], v[112:115], v[184:187], v[80:95]
  ds_read_b64_tr_b16 v[108:109], v10 offset:512
  ds_read_b64_tr_b16 v[110:111], v10 offset:1536
  s_waitcnt lgkmcnt(6)
  v_mfma_f32_32x32x16_bf16 v[64:79], v[96:99], v[188:191], v[64:79]
  ds_read_b64_tr_b16 v[112:113], v10 offset:2048
  ds_read_b64_tr_b16 v[114:115], v10 offset:3072
  s_add_u32 m0, s50, 81920
  s_xor_b32 s72, s83, 0
  buffer_load_dwordx4 v6, s[16:19], s72 offen lds
  s_waitcnt lgkmcnt(6)
  v_mfma_f32_32x32x16_bf16 v[80:95], v[100:103], v[188:191], v[80:95]
  ds_read_b64_tr_b16 v[96:97], v10 offset:2560
  ds_read_b64_tr_b16 v[98:99], v10 offset:3584
  v_xor_b32 v10, 49152, v11
  s_waitcnt vmcnt(18)
  s_barrier
  s_waitcnt vmcnt(13)
  v_max3_u32 v26, v192, v193, v194
  s_waitcnt vmcnt(12)
  v_max3_u32 v26, v26, v195, v196
  v_max3_u32 v26, v26, v197, v198
  v_max_u32 v26, v26, v199
  v_cmp_eq_u32 vcc, -1, v26
  s_nop 3
  s_cbranch_vccnz OVOK_25
VOK_25:
  s_waitcnt lgkmcnt(6)
  v_mfma_f32_32x32x16_bf16 v[64:79], v[104:107], v[192:195], v[64:79]
  ds_read_b64_tr_b16 v[100:101], v10 offset:0
  ds_read_b64_tr_b16 v[102:103], v10 offset:1024
  s_add_u32 s97, s81, 98304
  buffer_load_dwordx4 v[228:231], v1, s[40:43], s97 offen offset:1024 sc1
  s_add_u32 m0, s50, 82944
  s_nop 0
  buffer_load_dwordx4 v7, s[16:19], s72 offen lds
  s_waitcnt lgkmcnt(6)
  v_mfma_f32_32x32x16_bf16 v[80:95], v[108:111], v[192:195], v[80:95]
  ds_read_b64_tr_b16 v[104:105], v10 offset:512
  ds_read_b64_tr_b16 v[106:107], v10 offset:1536
  s_waitcnt lgkmcnt(6)
  v_mfma_f32_32x32x16_bf16 v[64:79], v[112:115], v[196:199], v[64:79]
  ds_read_b64_tr_b16 v[108:109], v10 offset:2048
  ds_read_b64_tr_b16 v[110:111], v10 offset:3072
  s_add_u32 s97, s82, 98304
  buffer_load_dwordx4 v[232:235], v1, s[40:43], s97 offen offset:0 sc1
  s_add_u32 m0, s50, 65536
  s_xor_b32 s72, s83, 131072
  buffer_load_dwordx4 v6, s[16:19], s72 offen lds
  s_waitcnt lgkmcnt(6)
  v_mfma_f32_32x32x16_bf16 v[80:95], v[96:99], v[196:199], v[80:95]
  ds_read_b64_tr_b16 v[112:113], v10 offset:2560
  ds_read_b64_tr_b16 v[114:115], v10 offset:3584
  v_xor_b32 v10, 98304, v11
  s_barrier
  s_waitcnt vmcnt(15)
  v_max3_u32 v26, v200, v201, v202
  s_waitcnt vmcnt(14)
  v_max3_u32 v26, v26, v203, v204
  v_max3_u32 v26, v26, v205, v206
  v_max_u32 v26, v26, v207
  v_cmp_eq_u32 vcc, -1, v26
  s_nop 3
  s_cbranch_vccnz OVOK_27
VOK_27:
  s_waitcnt lgkmcnt(6)
  v_mfma_f32_32x32x16_bf16 v[64:79], v[100:103], v[200:203], v[64:79]
  ds_read_b64_tr_b16 v[96:97], v10 offset:0
  ds_read_b64_tr_b16 v[98:99], v10 offset:1024
  s_add_u32 m0, s50, 66560
  s_nop 0
  buffer_load_dwordx4 v7, s[16:19], s72 offen lds
  s_waitcnt lgkmcnt(6)
  v_mfma_f32_32x32x16_bf16 v[80:95], v[104:107], v[200:203], v[80:95]
  ds_read_b64_tr_b16 v[100:101], v10 offset:512
  ds_read_b64_tr_b16 v[102:103], v10 offset:1536
  s_waitcnt lgkmcnt(6)
  v_mfma_f32_32x32x16_bf16 v[64:79], v[108:111], v[204:207], v[64:79]
  ds_read_b64_tr_b16 v[104:105], v10 offset:2048
  ds_read_b64_tr_b16 v[106:107], v10 offset:3072
  s_add_u32 s97, s82, 98304
  buffer_load_dwordx4 v[236:239], v1, s[40:43], s97 offen offset:1024 sc1
  v_lshrrev_b32 v19, 3, v0
  v_lshlrev_b32 v19, 10, v19
  v_and_b32 v20, 7, v0
  v_lshl_add_u32 v19, v20, 4, v19
  buffer_load_dwordx4 v[28:31], v19, s[4:7], s73 offen
  s_add_u32 s97, s77, 114688
  buffer_load_dwordx4 v[240:243], v1, s[40:43], s97 offen offset:0 sc1
  s_waitcnt lgkmcnt(6)
  v_mfma_f32_32x32x16_bf16 v[80:95], v[112:115], v[204:207], v[80:95]
  ds_read_b64_tr_b16 v[108:109], v10 offset:2560
  ds_read_b64_tr_b16 v[110:111], v10 offset:3584
  v_xor_b32 v10, 114688, v11
  s_barrier
  s_waitcnt vmcnt(17)
  v_max3_u32 v26, v208, v209, v210
  s_waitcnt vmcnt(15)
  v_max3_u32 v26, v26, v211, v212
  v_max3_u32 v26, v26, v213, v214
  v_max_u32 v26, v26, v215
  v_cmp_eq_u32 vcc, -1, v26
  s_nop 3
  s_cbranch_vccnz OVOK_29
VOK_29:
  s_waitcnt lgkmcnt(6)
  v_mfma_f32_32x32x16_bf16 v[64:79], v[96:99], v[208:211], v[64:79]
  ds_read_b64_tr_b16 v[112:113], v10 offset:0
  ds_read_b64_tr_b16 v[114:115], v10 offset:1024
  s_add_u32 m0, s50, 16384
  s_xor_b32 s72, s83, 262144
  buffer_load_dwordx4 v6, s[16:19], s72 offen lds
  s_waitcnt lgkmcnt(6)
  v_mfma_f32_32x32x16_bf16 v[80:95], v[100:103], v[208:211], v[80:95]
  ds_read_b64_tr_b16 v[96:97], v10 offset:512
  ds_read_b64_tr_b16 v[98:99], v10 offset:1536
  s_waitcnt lgkmcnt(6)
  v_mfma_f32_32x32x16_bf16 v[64:79], v[104:107], v[212:215], v[64:79]
  ds_read_b64_tr_b16 v[100:101], v10 offset:2048
  ds_read_b64_tr_b16 v[102:103], v10 offset:3072
  s_add_u32 s97, s77, 114688
  buffer_load_dwordx4 v[244:247], v1, s[40:43], s97 offen offset:1024 sc1
  s_add_u32 m0, s50, 17408
  s_nop 0
  buffer_load_dwordx4 v7, s[16:19], s72 offen lds
  s_waitcnt lgkmcnt(6)
  v_mfma_f32_32x32x16_bf16 v[80:95], v[108:111], v[212:215], v[80:95]
  ds_read_b64_tr_b16 v[104:105], v10 offset:2560
  ds_read_b64_tr_b16 v[106:107], v10 offset:3584
  v_xor_b32 v10, 131072, v11
  s_waitcnt vmcnt(17)
  s_barrier
  s_waitcnt vmcnt(16)
  v_max3_u32 v26, v216, v217, v218
  s_waitcnt vmcnt(13)
  v_max3_u32 v26, v26, v219, v220
  v_max3_u32 v26, v26, v221, v222
  v_max_u32 v26, v26, v223
  v_cmp_eq_u32 vcc, -1, v26
  s_nop 3
  s_cbranch_vccnz OVOK_31
VOK_31:
  s_waitcnt lgkmcnt(6)
  v_mfma_f32_32x32x16_bf16 v[64:79], v[112:115], v[216:219], v[64:79]
  ds_read_b64_tr_b16 v[108:109], v10 offset:0
  ds_read_b64_tr_b16 v[110:111], v10 offset:1024
  s_add_u32 s97, s78, 114688
  buffer_load_dwordx4 v[248:251], v1, s[40:43], s97 offen offset:0 sc1
  s_add_u32 m0, s50, 32768
  s_xor_b32 s72, s83, 393216
  buffer_load_dwordx4 v6, s[16:19], s72 offen lds
  s_waitcnt lgkmcnt(6)
  v_mfma_f32_32x32x16_bf16 v[80:95], v[96:99], v[216:219], v[80:95]
  ds_read_b64_tr_b16 v[112:113], v10 offset:512
  ds_read_b64_tr_b16 v[114:115], v10 offset:1536
  s_waitcnt lgkmcnt(6)
  v_mfma_f32_32x32x16_bf16 v[64:79], v[100:103], v[220:223], v[64:79]
  ds_read_b64_tr_b16 v[96:97], v10 offset:2048
  ds_read_b64_tr_b16 v[98:99], v10 offset:3072
  s_add_u32 m0, s50, 33792
  s_nop 0
  buffer_load_dwordx4 v7, s[16:19], s72 offen lds
  s_waitcnt lgkmcnt(6)
  v_mfma_f32_32x32x16_bf16 v[80:95], v[104:107], v[220:223], v[80:95]
  ds_read_b64_tr_b16 v[100:101], v10 offset:2560
  ds_read_b64_tr_b16 v[102:103], v10 offset:3584
  v_xor_b32 v10, 147456, v11
  s_barrier
  s_waitcnt vmcnt(15)
  v_max3_u32 v26, v224, v225, v226
  s_waitcnt vmcnt(13)
  v_max3_u32 v26, v26, v227, v228
  v_max3_u32 v26, v26, v229, v230
  v_max_u32 v26, v26, v231
  v_cmp_eq_u32 vcc, -1, v26
  s_nop 3
  s_cbranch_vccnz OVOK_33
VOK_33:
  s_waitcnt lgkmcnt(6)
  v_mfma_f32_32x32x16_bf16 v[64:79], v[108:111], v[224:227], v[64:79]
  ds_read_b64_tr_b16 v[104:105], v10 offset:0
  ds_read_b64_tr_b16 v[106:107], v10 offset:1024
  s_add_u32 s97, s78, 114688
  buffer_load_dwordx4 v[252:255], v1, s[40:43], s97 offen offset:1024 sc1
  s_add_u32 s97, s79, 114688
  buffer_load_dwordx4 v[128:131], v1, s[40:43], s97 offen offset:0 sc1
  s_waitcnt lgkmcnt(6)
  v_mfma_f32_32x32x16_bf16 v[80:95], v[112:115], v[224:227], v[80:95]
  ds_read_b64_tr_b16 v[108:109], v10 offset:512
  ds_read_b64_tr_b16 v[110:111], v10 offset:1536
  s_waitcnt lgkmcnt(6)
  v_mfma_f32_32x32x16_bf16 v[64:79], v[96:99], v[228:231], v[64:79]
  ds_read_b64_tr_b16 v[112:113], v10 offset:2048
  ds_read_b64_tr_b16 v[114:115], v10 offset:3072
  s_add_u32 s97, s79, 114688
  buffer_load_dwordx4 v[132:135], v1, s[40:43], s97 offen offset:1024 sc1
  s_waitcnt lgkmcnt(6)
  v_mfma_f32_32x32x16_bf16 v[80:95], v[100:103], v[228:231], v[80:95]
  ds_read_b64_tr_b16 v[96:97], v10 offset:2560
  ds_read_b64_tr_b16 v[98:99], v10 offset:3584
  v_xor_b32 v10, 81920, v11
  s_waitcnt vmcnt(15)
  s_barrier
  s_waitcnt vmcnt(14)
  v_max3_u32 v26, v232, v233, v234
  s_waitcnt vmcnt(11)
  v_max3_u32 v26, v26, v235, v236
  v_max3_u32 v26, v26, v237, v238
  v_max_u32 v26, v26, v239
  v_cmp_eq_u32 vcc, -1, v26
  s_nop 3
  s_cbranch_vccnz OVOK_35
VOK_35:
  s_waitcnt lgkmcnt(6)
  v_mfma_f32_32x32x16_bf16 v[64:79], v[104:107], v[232:235], v[64:79]
  ds_read_b64_tr_b16 v[100:101], v10 offset:0
  ds_read_b64_tr_b16 v[102:103], v10 offset:1024
  s_add_u32 s97, s80, 114688
  buffer_load_dwordx4 v[136:139], v1, s[40:43], s97 offen offset:0 sc1
  s_add_u32 s97, s80, 114688
  buffer_load_dwordx4 v[140:143], v1, s[40:43], s97 offen offset:1024 sc1
  s_waitcnt lgkmcnt(6)
  v_mfma_f32_32x32x16_bf16 v[80:95], v[108:111], v[232:235], v[80:95]
  ds_read_b64_tr_b16 v[104:105], v10 offset:512
  ds_read_b64_tr_b16 v[106:107], v10 offset:1536
  s_waitcnt lgkmcnt(6)
  v_mfma_f32_32x32x16_bf16 v[64:79], v[112:115], v[236:239], v[64:79]
  ds_read_b64_tr_b16 v[108:109], v10 offset:2048
  ds_read_b64_tr_b16 v[110:111], v10 offset:3072
  s_waitcnt lgkmcnt(6)
  v_mfma_f32_32x32x16_bf16 v[80:95], v[96:99], v[236:239], v[80:95]
  ds_read_b64_tr_b16 v[112:113], v10 offset:2560
  ds_read_b64_tr_b16 v[114:115], v10 offset:3584
  v_xor_b32 v10, 65536, v11
  s_barrier
  s_waitcnt vmcnt(11)
  v_max3_u32 v26, v240, v241, v242
  s_waitcnt vmcnt(9)
  v_max3_u32 v26, v26, v243, v244
  v_max3_u32 v26, v26, v245, v246
  v_max_u32 v26, v26, v247
  v_cmp_eq_u32 vcc, -1, v26
  s_nop 3
  s_cbranch_vccnz OVOK_37
VOK_37:
  s_waitcnt lgkmcnt(6)
  v_mfma_f32_32x32x16_bf16 v[64:79], v[100:103], v[240:243], v[64:79]
  ds_read_b64_tr_b16 v[96:97], v10 offset:0
  ds_read_b64_tr_b16 v[98:99], v10 offset:1024
  s_waitcnt lgkmcnt(6)
  v_mfma_f32_32x32x16_bf16 v[80:95], v[104:107], v[240:243], v[80:95]
  ds_read_b64_tr_b16 v[100:101], v10 offset:512
  ds_read_b64_tr_b16 v[102:103], v10 offset:1536
  s_waitcnt lgkmcnt(6)
  v_mfma_f32_32x32x16_bf16 v[64:79], v[108:111], v[244:247], v[64:79]
  ds_read_b64_tr_b16 v[104:105], v10 offset:2048
  ds_read_b64_tr_b16 v[106:107], v10 offset:3072
  s_waitcnt lgkmcnt(6)
  v_mfma_f32_32x32x16_bf16 v[80:95], v[112:115], v[244:247], v[80:95]
  ds_read_b64_tr_b16 v[108:109], v10 offset:2560
  ds_read_b64_tr_b16 v[110:111], v10 offset:3584
  v_xor_b32 v10, 16384, v11
  s_waitcnt vmcnt(8)
  s_barrier
  s_waitcnt vmcnt(7)
  v_max3_u32 v26, v248, v249, v250
  s_waitcnt vmcnt(4)
  v_max3_u32 v26, v26, v251, v252
  v_max3_u32 v26, v26, v253, v254
  v_max_u32 v26, v26, v255
  v_cmp_eq_u32 vcc, -1, v26
  s_nop 3
  s_cbranch_vccnz OVOK_39
VOK_39:
  s_waitcnt lgkmcnt(6)
  v_mfma_f32_32x32x16_bf16 v[64:79], v[96:99], v[248:251], v[64:79]
  ds_read_b64_tr_b16 v[112:113], v10 offset:0
  ds_read_b64_tr_b16 v[114:115], v10 offset:1024
  v_and_b32 v32, 31, v0
  v_lshrrev_b32 v33, 5, v0
  v_and_b32 v34, 7, v0
  v_xor_b32 v34, v34, v33
  v_lshlrev_b32 v34, 4, v34
  s_waitcnt lgkmcnt(6)
  v_mfma_f32_32x32x16_bf16 v[80:95], v[100:103], v[248:251], v[80:95]
  ds_read_b64_tr_b16 v[96:97], v10 offset:512
  ds_read_b64_tr_b16 v[98:99], v10 offset:1536
  v_lshl_add_u32 v32, v32, 8, v34
  s_lshr_b32 s56, s44, 1
  s_mov_b32 s57, 0
  s_cmp_eq_u32 s56, 1
  s_cselect_b32 s57, 49152, s57
  s_cmp_eq_u32 s56, 2
  s_cselect_b32 s57, 98304, s57
  s_cmp_eq_u32 s56, 3
  s_cselect_b32 s57, 114688, s57
  s_waitcnt lgkmcnt(6)
  v_mfma_f32_32x32x16_bf16 v[64:79], v[104:107], v[252:255], v[64:79]
  ds_read_b64_tr_b16 v[100:101], v10 offset:2048
  ds_read_b64_tr_b16 v[102:103], v10 offset:3072
  s_and_b32 s56, s44, 1
  s_lshl_b32 s56, s56, 13
  s_add_u32 s57, s57, s56
  v_add_u32 v32, s57, v32
  v_xor_b32 v33, 32, v32
  v_xor_b32 v34, 64, v32
  s_waitcnt lgkmcnt(6)
  v_mfma_f32_32x32x16_bf16 v[80:95], v[108:111], v[252:255], v[80:95]
  ds_read_b64_tr_b16 v[104:105], v10 offset:2560
  ds_read_b64_tr_b16 v[106:107], v10 offset:3584
  v_xor_b32 v35, 96, v32
  v_lshrrev_b32 v36, 3, v0
  v_and_b32 v37, 7, v0
  v_lshlrev_b32 v37, 1, v37
  v_xor_b32 v37, v37, v36
  v_xor_b32 v10, 32768, v11
  s_barrier
  s_waitcnt vmcnt(3)
  v_max3_u32 v26, v128, v129, v130
  s_waitcnt vmcnt(2)
  v_max3_u32 v26, v26, v131, v132
  v_max3_u32 v26, v26, v133, v134
  v_max_u32 v26, v26, v135
  v_cmp_eq_u32 vcc, -1, v26
  s_nop 3
  s_cbranch_vccnz OVOK_41
VOK_41:
  s_waitcnt lgkmcnt(6)
  v_mfma_f32_32x32x16_bf16 v[64:79], v[112:115], v[128:131], v[64:79]
  ds_read_b64_tr_b16 v[108:109], v10 offset:0
  ds_read_b64_tr_b16 v[110:111], v10 offset:1024
  v_lshlrev_b32 v37, 4, v37
  v_lshl_add_u32 v36, v36, 8, v37
  v_add_u32 v36, s50, v36
  v_add_u32 v48, 0, v36
  v_xor_b32 v49, 16, v48
  s_waitcnt lgkmcnt(6)
  v_mfma_f32_32x32x16_bf16 v[80:95], v[96:99], v[128:131], v[80:95]
  ds_read_b64_tr_b16 v[112:113], v10 offset:512
  ds_read_b64_tr_b16 v[114:115], v10 offset:1536
  v_add_u32 v50, 49152, v36
  v_xor_b32 v51, 16, v50
  v_add_u32 v52, 98304, v36
  v_xor_b32 v53, 16, v52
  v_add_u32 v54, 114688, v36
  s_waitcnt lgkmcnt(6)
  v_mfma_f32_32x32x16_bf16 v[64:79], v[100:103], v[132:135], v[64:79]
  ds_read_b64_tr_b16 v[96:97], v10 offset:2048
  ds_read_b64_tr_b16 v[98:99], v10 offset:3072
  v_xor_b32 v55, 16, v54
  v_lshlrev_b32 v40, 16, v28
  v_and_b32 v41, 0xffff0000, v28
  v_lshlrev_b32 v42, 16, v29
  v_and_b32 v43, 0xffff0000, v29
  s_waitcnt lgkmcnt(6)
  v_mfma_f32_32x32x16_bf16 v[80:95], v[104:107], v[132:135], v[80:95]
  ds_read_b64_tr_b16 v[100:101], v10 offset:2560
  ds_read_b64_tr_b16 v[102:103], v10 offset:3584
  v_lshlrev_b32 v44, 16, v30
  v_and_b32 v45, 0xffff0000, v30
  v_lshlrev_b32 v46, 16, v31
  v_and_b32 v47, 0xffff0000, v31
  s_waitcnt vmcnt(1)
  v_max3_u32 v26, v136, v137, v138
  s_waitcnt vmcnt(0)
  v_max3_u32 v26, v26, v139, v140
  v_max3_u32 v26, v26, v141, v142
  v_max_u32 v26, v26, v143
  v_cmp_eq_u32 vcc, -1, v26
  s_nop 3
  s_cbranch_vccnz OVOK_43
VOK_43:
  s_waitcnt lgkmcnt(6)
  v_mfma_f32_32x32x16_bf16 v[64:79], v[108:111], v[136:139], v[64:79]
  s_waitcnt lgkmcnt(4)
  v_mfma_f32_32x32x16_bf16 v[80:95], v[112:115], v[136:139], v[80:95]
  s_waitcnt lgkmcnt(2)
  v_mfma_f32_32x32x16_bf16 v[64:79], v[96:99], v[140:143], v[64:79]
  s_waitcnt lgkmcnt(0)
  v_mfma_f32_32x32x16_bf16 v[80:95], v[100:103], v[140:143], v[80:95]
  s_nop 9
  ds_write_b128 v32, v[64:67] offset:0
  ds_write_b128 v33, v[68:71] offset:0
  ds_write_b128 v34, v[72:75] offset:0
  ds_write_b128 v35, v[76:79] offset:0
  ds_write_b128 v32, v[80:83] offset:128
  ds_write_b128 v33, v[84:87] offset:128
  ds_write_b128 v34, v[88:91] offset:128
  ds_write_b128 v35, v[92:95] offset:128
  s_waitcnt lgkmcnt(0)
  s_barrier
  ds_read_b128 v[160:163], v48
  ds_read_b128 v[164:167], v49
  ds_read_b128 v[168:171], v50
  ds_read_b128 v[172:175], v51
  ds_read_b128 v[176:179], v52
  ds_read_b128 v[180:183], v53
  ds_read_b128 v[184:187], v54
  ds_read_b128 v[188:191], v55
  s_waitcnt lgkmcnt(7)
  v_add_f32 v40, v40, v160
  v_add_f32 v41, v41, v161
  v_add_f32 v42, v42, v162
  v_add_f32 v43, v43, v163
  s_waitcnt lgkmcnt(6)
  v_add_f32 v44, v44, v164
  v_add_f32 v45, v45, v165
  v_add_f32 v46, v46, v166
  v_add_f32 v47, v47, v167
  s_waitcnt lgkmcnt(5)
  v_add_f32 v40, v40, v168
  v_add_f32 v41, v41, v169
  v_add_f32 v42, v42, v170
  v_add_f32 v43, v43, v171
  s_waitcnt lgkmcnt(4)
  v_add_f32 v44, v44, v172
  v_add_f32 v45, v45, v173
  v_add_f32 v46, v46, v174
  v_add_f32 v47, v47, v175
  s_waitcnt lgkmcnt(3)
  v_add_f32 v40, v40, v176
  v_add_f32 v41, v41, v177
  v_add_f32 v42, v42, v178
  v_add_f32 v43, v43, v179
  s_waitcnt lgkmcnt(2)
  v_add_f32 v44, v44, v180
  v_add_f32 v45, v45, v181
  v_add_f32 v46, v46, v182
  v_add_f32 v47, v47, v183
  s_waitcnt lgkmcnt(1)
  v_add_f32 v40, v40, v184
  v_add_f32 v41, v41, v185
  v_add_f32 v42, v42, v186
  v_add_f32 v43, v43, v187
  s_waitcnt lgkmcnt(0)
  v_add_f32 v44, v44, v188
  v_add_f32 v45, v45, v189
  v_add_f32 v46, v46, v190
  v_add_f32 v47, v47, v191
  v_cvt_pk_bf16_f32 v120, v40, v41
  v_cvt_pk_bf16_f32 v121, v42, v43
  v_cvt_pk_bf16_f32 v122, v44, v45
  v_cvt_pk_bf16_f32 v123, v46, v47
  buffer_store_dwordx4 v[120:123], v19, s[32:35], s73 offen
  s_endpgm
L_TYPEQ:
  s_add_u32 m0, s50, 16384
  s_nop 0
  buffer_load_dwordx4 v6, s[4:7], s85 offen lds
  s_add_u32 m0, s50, 17408
  s_nop 0
  buffer_load_dwordx4 v7, s[4:7], s85 offen lds
  s_mul_i32 s77, s85, 1792
  s_mul_i32 s56, s44, 28672
  s_lshl_b32 s57, s48, 7
  s_add_u32 s56, s56, s57
  v_bfe_u32 v192, v0, 2, 3
  v_mul_u32_u24 v192, 3584, v192
  v_lshrrev_b32 v193, 5, v0
  v_lshl_add_u32 v192, v193, 6, v192
  v_and_b32 v193, 3, v0
  v_lshl_add_u32 v192, v193, 4, v192
  v_add_u32 v2, s56, v192
  v_xor_b32 v3, 32, v2
  s_add_u32 m0, s49, 81920
  s_nop 0
  buffer_load_dwordx4 v2, s[20:23], s77 offen lds
  s_add_u32 m0, s49, 90112
  s_nop 0
  buffer_load_dwordx4 v3, s[24:27], s77 offen lds
  s_mul_i32 s78, s86, 1792
  s_mul_i32 s79, s87, 1792
  s_mul_i32 s80, s88, 1792
  s_mul_i32 s81, s89, 1792
  s_mul_i32 s82, s90, 1792
  s_mul_i32 s83, s91, 1792
  s_mul_i32 s84, s92, 1792
  s_min_u32 s3, s44, 1
  s_lshl_b32 s3, s3, 30
  s_and_b32 s45, s44, 3
  s_lshr_b32 s46, s44, 2
  s_lshl_b32 s100, s46, 1
  s_xor_b32 s100, s100, s45
  v_bfe_u32 v240, v0, 4, 1
  v_lshrrev_b32 v241, 5, v0
  v_bfe_u32 v242, v0, 2, 2
  v_and_b32 v243, 3, v0
  v_lshlrev_b32 v243, 3, v243
  v_lshl_add_u32 v244, v242, 6, v243
  v_xor_b32 v245, s46, v240
  v_lshl_add_u32 v245, v245, 5, v244
  v_lshl_add_u32 v245, v240, 13, v245
  v_lshl_add_u32 v8, v241, 10, v245
  s_lshl_b32 s56, s100, 11
  v_add_u32 v8, s56, v8
  v_and_b32 v246, 31, v0
  v_bfe_u32 v247, v0, 1, 3
  v_xor_b32 v247, v247, v241
  s_lshl_b32 s57, s100, 1
  v_xor_b32 v247, s57, v247
  v_lshlrev_b32 v247, 4, v247
  v_lshl_add_u32 v11, v246, 7, v247
  s_lshl_b32 s57, s45, 12
  s_add_u32 s57, s57, 16384
  v_add_u32 v84, s57, v11
  v_xor_b32 v85, 32, v84
  v_xor_b32 v86, 64, v84
  v_xor_b32 v87, 96, v84
  v_bfe_u32 v247, v0, 2, 1
  s_add_u32 m0, s50, 32768
  s_nop 0
  buffer_load_dwordx4 v6, s[4:7], s86 offen lds
  v_cmp_eq_u32 vcc, v247, v240
  v_mov_b32 v22, 0x3f803f80
  s_nop 0
  v_cndmask_b32 v28, 0, v22, vcc
  v_cndmask_b32 v29, 0, v22, vcc
  v_cndmask_b32 v30, 0, v22, vcc
  v_cndmask_b32 v31, 0, v22, vcc
  s_cmp_lg_u32 s46, 0
  v_lshl_add_u32 v245, v240, 5, v244
  v_lshl_add_u32 v9, v241, 10, v245
  s_lshl_b32 s56, s100, 11
  s_lshl_b32 s57, s46, 9
  s_add_u32 s56, s56, s57
  v_add_u32 v9, s56, v9
  s_lshl_b32 s56, s48, 3
  s_add_u32 s56, s56, s44
  s_lshl_b32 s56, s56, 4
  s_add_u32 m0, s50, 33792
  s_nop 0
  buffer_load_dwordx4 v7, s[4:7], s86 offen lds
  s_lshl_b32 s64, s56, 9
  s_add_u32 s64, s64, 9437184
  s_lshl_b32 s65, s56, 5
  s_add_u32 s65, s65, 9961472
  s_lshl_b32 s57, s44, 5
  s_add_u32 s56, s57, s85
  s_and_b32 s56, s56, 1023
  s_mul_i32 s93, s56, 1536
  s_add_u32 s56, s57, s87
  s_and_b32 s56, s56, 1023
  s_mul_i32 s94, s56, 1536
  s_add_u32 s56, s57, s89
  s_and_b32 s56, s56, 1023
  s_mul_i32 s95, s56, 1536
  s_add_u32 s56, s57, s91
  s_and_b32 s56, s56, 1023
  s_add_u32 m0, s49, 98304
  s_nop 0
  buffer_load_dwordx4 v2, s[20:23], s78 offen lds
  s_mul_i32 s96, s56, 1536
  s_lshl_b32 s56, s48, 7
  v_bfe_u32 v248, v0, 2, 3
  v_mul_u32_u24 v248, 3072, v248
  v_lshrrev_b32 v249, 5, v0
  v_lshl_add_u32 v248, v249, 6, v248
  v_and_b32 v249, 3, v0
  v_lshl_add_u32 v248, v249, 4, v248
  v_add_u32 v4, s56, v248
  v_add_u32 v5, 24576, v4
  s_lshl_b32 s99, s46, 11
  s_lshl_b32 s56, s45, 3
  s_add_u32 s99, s99, s56
  s_lshl_b32 s56, s47, 2
  s_add_u32 s56, s56, s45
  s_mul_i32 s56, s56, 147456
  s_add_u32 m0, s49, 106496
  s_nop 0
  buffer_load_dwordx4 v3, s[24:27], s78 offen lds
  s_lshl_b32 s57, s48, 2
  s_add_u32 s57, s57, s46
  s_lshl_b32 s58, s57, 10
  s_add_u32 s60, s56, s58
  s_lshl_b32 s57, s48, 1
  s_add_u32 s57, s57, s46
  s_lshl_b32 s58, s57, 11
  s_add_u32 s61, s56, s58
  s_lshl_b32 s63, s47, 9
  s_lshl_b32 s56, s48, 3
  s_add_u32 s63, s63, s56
  s_add_u32 s63, s63, 9994240
  s_and_b32 s56, s2, 7
  s_lshl_b32 s56, s56, 2
  s_and_b32 s57, s52, 3
  s_add_u32 s56, s56, s57
  s_lshr_b32 s76, s56, 1
  s_lshl_b32 s76, s76, 9
  s_lshr_b32 s57, s52, 2
  s_lshl_b32 s57, s57, 7
  s_lshl_b32 s73, s56, 16
  s_add_u32 s73, s73, s57
  s_lshl_b32 s58, s44, 13
  s_add_u32 s73, s73, s58
  s_lshl_b32 s58, s44, 14
  s_add_u32 s53, s58, s57
  s_lshl_b32 s56, s56, 1
  s_and_b32 s57, s44, 1
  s_add_u32 s56, s56, s57
  s_mul_i32 s62, s56, 147456
  s_lshr_b32 s57, s44, 1
  s_lshl_b32 s57, s57, 11
  s_add_u32 s62, s62, s57
  v_lshl_add_u32 v248, v241, 2, v242
  v_lshlrev_b32 v17, 5, v248
  v_lshl_add_u32 v17, v240, 4, v17
  v_and_b32 v248, 2, v0
  v_lshl_add_u32 v17, v248, 2, v17
  s_lshl_b32 s56, s46, 10
  v_add_u32 v17, s56, v17
  v_mul_u32_u24 v248, 0x8000, v247
  v_lshl_or_b32 v18, v248, 16, v248
  v_min_u32 v248, 16, v246
  v_lshlrev_b32 v248, 6, v248
  v_lshl_add_u32 v248, v241, 5, v248
  s_lshl_b32 s56, s46, 12
  v_add_u32 v16, s56, v248
  v_lshl_add_u32 v11, v240, 5, v244
  v_lshl_add_u32 v11, v241, 8, v11
  s_lshr_b32 s56, s44, 1
  s_lshl_b32 s56, s56, 12
  v_add_u32 v11, s56, v11
  s_lshl_b32 s56, s44, 8
  s_lshl_b32 s57, s48, 11
  s_add_u32 s57, s57, s56
  v_lshlrev_b32 v248, 2, v0
  s_add_u32 m0, s56, 512
  s_nop 0
  buffer_load_dword v248, s[12:15], s57 offen lds
  s_waitcnt vmcnt(9)
  v_dot2_f32_bf16 v68, v64, v22, 0
  v_dot2_f32_bf16 v69, v64, v64, 0
  v_dot2_f32_bf16 v68, v65, v22, v68
  v_dot2_f32_bf16 v69, v65, v65, v69
  v_dot2_f32_bf16 v68, v66, v22, v68
  v_dot2_f32_bf16 v69, v66, v66, v69
  v_dot2_f32_bf16 v68, v67, v22, v68
  v_dot2_f32_bf16 v69, v67, v67, v69
  s_nop 1
  v_add_f32_dpp v68, v68, v68 quad_perm:[1,0,3,2] row_mask:0xf bank_mask:0xf
  v_add_f32_dpp v69, v69, v69 quad_perm:[1,0,3,2] row_mask:0xf bank_mask:0xf
  s_nop 0
  v_add_f32_dpp v68, v68, v68 quad_perm:[2,3,0,1] row_mask:0xf bank_mask:0xf
  v_add_f32_dpp v69, v69, v69 quad_perm:[2,3,0,1] row_mask:0xf bank_mask:0xf
  s_nop 0
  v_add_f32_dpp v68, v68, v68 row_half_mirror row_mask:0xf bank_mask:0xf
  v_add_f32_dpp v69, v69, v69 row_half_mirror row_mask:0xf bank_mask:0xf
  s_nop 0
  v_add_f32_dpp v68, v68, v68 row_mirror row_mask:0xf bank_mask:0xf
  v_add_f32_dpp v69, v69, v69 row_mirror row_mask:0xf bank_mask:0xf
  v_mov_b32 v70, v68
  v_mov_b32 v71, v69
  s_nop 0
  v_permlane16_swap_b32 v68, v70
  v_permlane16_swap_b32 v69, v71
  v_add_f32 v68, v68, v70
  v_add_f32 v69, v69, v71
  v_mov_b32 v70, v68
  v_mov_b32 v71, v69
  s_nop 0
  v_permlane32_swap_b32 v68, v70
  v_permlane32_swap_b32 v69, v71
  v_add_f32 v68, v68, v70
  v_add_f32 v69, v69, v71
  v_mul_f32 v68, 0xbb000000, v68
  v_mul_f32 v69, 0x3b000000, v69
  v_mul_f32 v70, v68, v68
  v_sub_f32 v69, v69, v70
  v_max_f32 v69, 0, v69
  v_add_f32 v69, 0x3727c5ac, v69
  s_lshl_b32 s56, s44, 3
  v_mov_b32 v70, s56
  ds_write_b64 v70, v[68:69] offset:4096
  s_mov_b32 s0, 20000
  s_mov_b32 s67, 0
  s_waitcnt lgkmcnt(0)
  buffer_load_dwordx2 v[72:73], off, s[36:39], s3 sc1
  s_waitcnt vmcnt(6)
  s_barrier
  v_xor_b32 v10, 81920, v8
  ds_read_b128 v[128:131], v84 offset:0
  ds_read_b64_tr_b16 v[96:97], v10 offset:0
  ds_read_b64_tr_b16 v[98:99], v10 offset:256
  ds_read_b64_tr_b16 v[100:101], v10 offset:512
  ds_read_b64_tr_b16 v[102:103], v10 offset:768
  v_xor_b32 v10, 83968, v8
  ds_read_b128 v[132:135], v85 offset:0
  ds_read_b64_tr_b16 v[104:105], v10 offset:0
  ds_read_b64_tr_b16 v[106:107], v10 offset:256
  ds_read_b64_tr_b16 v[108:109], v10 offset:512
  ds_read_b64_tr_b16 v[110:111], v10 offset:768
  v_xor_b32 v10, 86016, v8
  ds_read_b128 v[136:139], v86 offset:0
  ds_read_b128 v[140:143], v87 offset:0
  s_waitcnt lgkmcnt(9)
  v_mfma_f32_32x32x16_bf16 v[32:47], v[96:99], v[128:131], 0
  ds_read_b64_tr_b16 v[112:113], v10 offset:0
  ds_read_b64_tr_b16 v[114:115], v10 offset:256
  v_and_b32 v82, 7, v0
  v_lshlrev_b32 v82, 3, v82
  ds_read_b64 v[80:81], v82 offset:4096
  s_add_u32 m0, s50, 49152
  s_nop 0
  buffer_load_dwordx4 v6, s[4:7], s87 offen lds
  v_mfma_f32_16x16x32_bf16 v[88:91], v[28:31], v[96:99], 0
  s_waitcnt lgkmcnt(10)
  v_mfma_f32_32x32x16_bf16 v[48:63], v[100:103], v[128:131], 0
  ds_read_b64_tr_b16 v[96:97], v10 offset:512
  ds_read_b64_tr_b16 v[98:99], v10 offset:768
  s_add_u32 m0, s50, 50176
  v_xor_b32 v10, 88064, v8
  buffer_load_dwordx4 v7, s[4:7], s87 offen lds
  v_mfma_f32_16x16x32_bf16 v[92:95], v[28:31], v[100:103], 0
  s_waitcnt lgkmcnt(9)
  v_mfma_f32_32x32x16_bf16 v[32:47], v[104:107], v[132:135], v[32:47]
  ds_read_b64_tr_b16 v[100:101], v10 offset:0
  ds_read_b64_tr_b16 v[102:103], v10 offset:256
  s_add_u32 m0, s49, 114688
  s_nop 0
  buffer_load_dwordx4 v2, s[20:23], s79 offen lds
  s_waitcnt lgkmcnt(9)
  v_mfma_f32_32x32x16_bf16 v[48:63], v[108:111], v[132:135], v[48:63]
  ds_read_b64_tr_b16 v[104:105], v10 offset:512
  ds_read_b64_tr_b16 v[106:107], v10 offset:768
  s_add_u32 m0, s49, 122880
  v_xor_b32 v10, 98304, v8
  buffer_load_dwordx4 v3, s[24:27], s79 offen lds
  buffer_load_dwordx2 v[74:75], off, s[36:39], s3 sc1
  s_waitcnt vmcnt(7) lgkmcnt(6)
  s_barrier
  v_mfma_f32_32x32x16_bf16 v[32:47], v[112:115], v[136:139], v[32:47]
  ds_read_b64_tr_b16 v[108:109], v10 offset:0
  ds_read_b64_tr_b16 v[110:111], v10 offset:256
  ds_read_b128 v[144:147], v84 offset:16384
  s_add_u32 m0, s50, 65536
  s_nop 0
  buffer_load_dwordx4 v6, s[4:7], s88 offen lds
  s_waitcnt lgkmcnt(7)
  v_mfma_f32_32x32x16_bf16 v[48:63], v[96:99], v[136:139], v[48:63]
  ds_read_b64_tr_b16 v[112:113], v10 offset:512
  ds_read_b64_tr_b16 v[114:115], v10 offset:768
  ds_read_b128 v[148:151], v85 offset:16384
  s_add_u32 m0, s50, 66560
  v_xor_b32 v10, 100352, v8
  buffer_load_dwordx4 v7, s[4:7], s88 offen lds
  s_waitcnt lgkmcnt(8)
  v_mfma_f32_32x32x16_bf16 v[32:47], v[100:103], v[140:143], v[32:47]
  ds_read_b64_tr_b16 v[96:97], v10 offset:0
  ds_read_b64_tr_b16 v[98:99], v10 offset:256
  ds_read_b128 v[152:155], v86 offset:16384
  s_add_u32 m0, s49, 131072
  s_nop 0
  buffer_load_dwordx4 v2, s[20:23], s80 offen lds
  s_waitcnt lgkmcnt(9)
  v_mfma_f32_32x32x16_bf16 v[48:63], v[104:107], v[140:143], v[48:63]
  ds_read_b64_tr_b16 v[100:101], v10 offset:512
  ds_read_b64_tr_b16 v[102:103], v10 offset:768
  ds_read_b128 v[156:159], v87 offset:16384
  s_add_u32 m0, s49, 139264
  v_xor_b32 v10, 102400, v8
  buffer_load_dwordx4 v3, s[24:27], s80 offen lds
  s_waitcnt lgkmcnt(9)
  v_mfma_f32_32x32x16_bf16 v[32:47], v[108:111], v[144:147], v[32:47]
  ds_read_b64_tr_b16 v[104:105], v10 offset:0
  ds_read_b64_tr_b16 v[106:107], v10 offset:256
  s_add_u32 m0, s50, 16384
  s_nop 0
  buffer_load_dwordx4 v6, s[4:7], s89 offen lds
  v_mfma_f32_16x16x32_bf16 v[88:91], v[28:31], v[108:111], v[88:91]
  s_waitcnt lgkmcnt(9)
  v_mfma_f32_32x32x16_bf16 v[48:63], v[112:115], v[144:147], v[48:63]
  ds_read_b64_tr_b16 v[108:109], v10 offset:512
  ds_read_b64_tr_b16 v[110:111], v10 offset:768
  s_add_u32 m0, s50, 17408
  v_xor_b32 v10, 104448, v8
  buffer_load_dwordx4 v7, s[4:7], s89 offen lds
  v_mfma_f32_16x16x32_bf16 v[92:95], v[28:31], v[112:115], v[92:95]
  s_waitcnt lgkmcnt(8)
  v_mfma_f32_32x32x16_bf16 v[32:47], v[96:99], v[148:151], v[32:47]
  ds_read_b64_tr_b16 v[112:113], v10 offset:0
  ds_read_b64_tr_b16 v[114:115], v10 offset:256
  s_add_u32 m0, s49, 147456
  s_nop 0
  buffer_load_dwordx4 v2, s[20:23], s81 offen lds
  s_waitcnt lgkmcnt(7)
  v_mfma_f32_32x32x16_bf16 v[48:63], v[100:103], v[148:151], v[48:63]
  ds_read_b64_tr_b16 v[96:97], v10 offset:512
  ds_read_b64_tr_b16 v[98:99], v10 offset:768
  s_add_u32 m0, s49, 155648
  v_xor_b32 v10, 114688, v8
  buffer_load_dwordx4 v3, s[24:27], s81 offen lds
  buffer_load_dwordx2 v[76:77], off, s[36:39], s3 sc1
  s_waitcnt vmcnt(10) lgkmcnt(8)
  s_or_b32 s51, s44, s67
  s_cmp_lg_u32 s51, 0
  s_cbranch_scc0 OSOK_45
SOK_45:
  s_barrier
  s_waitcnt lgkmcnt(6)
  v_mfma_f32_32x32x16_bf16 v[32:47], v[104:107], v[152:155], v[32:47]
  ds_read_b64_tr_b16 v[100:101], v10 offset:0
  ds_read_b64_tr_b16 v[102:103], v10 offset:256
  ds_read_b128 v[160:163], v84 offset:32768
  s_add_u32 m0, s50, 32768
  s_nop 0
  buffer_load_dwordx4 v6, s[4:7], s90 offen lds
  s_waitcnt lgkmcnt(7)
  v_mfma_f32_32x32x16_bf16 v[48:63], v[108:111], v[152:155], v[48:63]
  ds_read_b64_tr_b16 v[104:105], v10 offset:512
  ds_read_b64_tr_b16 v[106:107], v10 offset:768
  ds_read_b128 v[164:167], v85 offset:32768
  v_xor_b32 v10, 116736, v8
  s_waitcnt lgkmcnt(8)
  v_mfma_f32_32x32x16_bf16 v[32:47], v[112:115], v[156:159], v[32:47]
  ds_read_b64_tr_b16 v[108:109], v10 offset:0
  ds_read_b64_tr_b16 v[110:111], v10 offset:256
  ds_read_b128 v[168:171], v86 offset:32768
  s_add_u32 m0, s50, 33792
  s_nop 0
  buffer_load_dwordx4 v7, s[4:7], s90 offen lds
  s_waitcnt lgkmcnt(9)
  v_mfma_f32_32x32x16_bf16 v[48:63], v[96:99], v[156:159], v[48:63]
  ds_read_b64_tr_b16 v[112:113], v10 offset:512
  ds_read_b64_tr_b16 v[114:115], v10 offset:768
  ds_read_b128 v[172:175], v87 offset:32768
  v_xor_b32 v10, 118784, v8
  s_waitcnt lgkmcnt(9)
  v_mfma_f32_32x32x16_bf16 v[32:47], v[100:103], v[160:163], v[32:47]
  ds_read_b64_tr_b16 v[96:97], v10 offset:0
  ds_read_b64_tr_b16 v[98:99], v10 offset:256
  s_add_u32 m0, s49, 81920
  s_nop 0
  buffer_load_dwordx4 v2, s[20:23], s82 offen lds
  v_mfma_f32_16x16x32_bf16 v[88:91], v[28:31], v[100:103], v[88:91]
  s_waitcnt lgkmcnt(9)
  v_mfma_f32_32x32x16_bf16 v[48:63], v[104:107], v[160:163], v[48:63]
  ds_read_b64_tr_b16 v[100:101], v10 offset:512
  ds_read_b64_tr_b16 v[102:103], v10 offset:768
  v_xor_b32 v10, 120832, v8
  v_mfma_f32_16x16x32_bf16 v[92:95], v[28:31], v[104:107], v[92:95]
  s_waitcnt lgkmcnt(8)
  v_mfma_f32_32x32x16_bf16 v[32:47], v[108:111], v[164:167], v[32:47]
  ds_read_b64_tr_b16 v[104:105], v10 offset:0
  ds_read_b64_tr_b16 v[106:107], v10 offset:256
  s_add_u32 m0, s49, 90112
  s_nop 0
  buffer_load_dwordx4 v3, s[24:27], s82 offen lds
  s_waitcnt lgkmcnt(7)
  v_mfma_f32_32x32x16_bf16 v[48:63], v[112:115], v[164:167], v[48:63]
  ds_read_b64_tr_b16 v[108:109], v10 offset:512
  ds_read_b64_tr_b16 v[110:111], v10 offset:768
  v_xor_b32 v10, 131072, v8
  s_waitcnt vmcnt(9) lgkmcnt(8)
  s_or_b32 s51, s44, s67
  s_cmp_lg_u32 s51, 0
  s_cbranch_scc0 OSOK_48
SOK_48:
  s_barrier
  s_waitcnt lgkmcnt(6)
  v_mfma_f32_32x32x16_bf16 v[32:47], v[96:99], v[168:171], v[32:47]
  ds_read_b64_tr_b16 v[112:113], v10 offset:0
  ds_read_b64_tr_b16 v[114:115], v10 offset:256
  ds_read_b128 v[176:179], v84 offset:49152
  s_add_u32 m0, s50, 49152
  s_nop 0
  buffer_load_dwordx4 v6, s[4:7], s91 offen lds
  s_waitcnt lgkmcnt(7)
  v_mfma_f32_32x32x16_bf16 v[48:63], v[100:103], v[168:171], v[48:63]
  ds_read_b64_tr_b16 v[96:97], v10 offset:512
  ds_read_b64_tr_b16 v[98:99], v10 offset:768
  ds_read_b128 v[180:183], v85 offset:49152
  v_xor_b32 v10, 133120, v8
  s_waitcnt lgkmcnt(8)
  v_mfma_f32_32x32x16_bf16 v[32:47], v[104:107], v[172:175], v[32:47]
  ds_read_b64_tr_b16 v[100:101], v10 offset:0
  ds_read_b64_tr_b16 v[102:103], v10 offset:256
  ds_read_b128 v[184:187], v86 offset:49152
  s_add_u32 m0, s50, 50176
  s_nop 0
  buffer_load_dwordx4 v7, s[4:7], s91 offen lds
  s_waitcnt lgkmcnt(9)
  v_mfma_f32_32x32x16_bf16 v[48:63], v[108:111], v[172:175], v[48:63]
  ds_read_b64_tr_b16 v[104:105], v10 offset:512
  ds_read_b64_tr_b16 v[106:107], v10 offset:768
  ds_read_b128 v[188:191], v87 offset:49152
  v_xor_b32 v10, 135168, v8
  s_waitcnt lgkmcnt(9)
  v_mfma_f32_32x32x16_bf16 v[32:47], v[112:115], v[176:179], v[32:47]
  ds_read_b64_tr_b16 v[108:109], v10 offset:0
  ds_read_b64_tr_b16 v[110:111], v10 offset:256
  s_add_u32 m0, s49, 98304
  s_nop 0
  buffer_load_dwordx4 v2, s[20:23], s83 offen lds
  v_mfma_f32_16x16x32_bf16 v[88:91], v[28:31], v[112:115], v[88:91]
  s_waitcnt lgkmcnt(9)
  v_mfma_f32_32x32x16_bf16 v[48:63], v[96:99], v[176:179], v[48:63]
  ds_read_b64_tr_b16 v[112:113], v10 offset:512
  ds_read_b64_tr_b16 v[114:115], v10 offset:768
  v_xor_b32 v10, 137216, v8
  v_mfma_f32_16x16x32_bf16 v[92:95], v[28:31], v[96:99], v[92:95]
  s_waitcnt lgkmcnt(8)
  v_mfma_f32_32x32x16_bf16 v[32:47], v[100:103], v[180:183], v[32:47]
  ds_read_b64_tr_b16 v[96:97], v10 offset:0
  ds_read_b64_tr_b16 v[98:99], v10 offset:256
  s_add_u32 m0, s49, 106496
  s_nop 0
  buffer_load_dwordx4 v3, s[24:27], s83 offen lds
  s_waitcnt lgkmcnt(7)
  v_mfma_f32_32x32x16_bf16 v[48:63], v[104:107], v[180:183], v[48:63]
  ds_read_b64_tr_b16 v[100:101], v10 offset:512
  ds_read_b64_tr_b16 v[102:103], v10 offset:768
  v_xor_b32 v10, 147456, v8
  s_waitcnt vmcnt(9) lgkmcnt(8)
  s_or_b32 s51, s44, s67
  s_cmp_lg_u32 s51, 0
  s_cbranch_scc0 OSOK_51
SOK_51:
  s_barrier
  s_waitcnt lgkmcnt(6)
  v_mfma_f32_32x32x16_bf16 v[32:47], v[108:111], v[184:187], v[32:47]
  ds_read_b64_tr_b16 v[104:105], v10 offset:0
  ds_read_b64_tr_b16 v[106:107], v10 offset:256
  ds_read_b128 v[192:195], v84 offset:0
  s_lshl_b32 s97, s2, 3
  s_add_u32 s97, s97, s44
  s_mul_i32 s98, s97, 896
  v_min_u32 v124, 6, v0
  v_lshlrev_b32 v124, 7, v124
  s_add_u32 m0, s50, 65536
  s_nop 0
  buffer_load_dwordx4 v6, s[4:7], s92 offen lds
  s_waitcnt lgkmcnt(7)
  v_mfma_f32_32x32x16_bf16 v[48:63], v[112:115], v[184:187], v[48:63]
  ds_read_b64_tr_b16 v[108:109], v10 offset:512
  ds_read_b64_tr_b16 v[110:111], v10 offset:768
  ds_read_b128 v[196:199], v85 offset:0
  buffer_load_dword v125, v124, s[28:31], s98 offen
  s_lshl_b32 s98, s97, 8
  v_and_b32 v124, 128, v124
  buffer_load_dword v126, v124, s[16:19], s98 offen
  v_xor_b32 v10, 149504, v8
  s_waitcnt lgkmcnt(8)
  v_mfma_f32_32x32x16_bf16 v[32:47], v[96:99], v[188:191], v[32:47]
  ds_read_b64_tr_b16 v[112:113], v10 offset:0
  ds_read_b64_tr_b16 v[114:115], v10 offset:256
  ds_read_b128 v[200:203], v86 offset:0
  s_add_u32 m0, s50, 66560
  s_nop 0
  buffer_load_dwordx4 v7, s[4:7], s92 offen lds
  s_waitcnt lgkmcnt(9)
  v_mfma_f32_32x32x16_bf16 v[48:63], v[100:103], v[188:191], v[48:63]
  ds_read_b64_tr_b16 v[96:97], v10 offset:512
  ds_read_b64_tr_b16 v[98:99], v10 offset:768
  ds_read_b128 v[204:207], v87 offset:0
  v_xor_b32 v10, 151552, v8
  s_waitcnt lgkmcnt(9)
  v_mfma_f32_32x32x16_bf16 v[32:47], v[104:107], v[192:195], v[32:47]
  ds_read_b64_tr_b16 v[100:101], v10 offset:0
  ds_read_b64_tr_b16 v[102:103], v10 offset:256
  s_add_u32 m0, s49, 114688
  s_nop 0
  buffer_load_dwordx4 v2, s[20:23], s84 offen lds
  v_mfma_f32_16x16x32_bf16 v[88:91], v[28:31], v[104:107], v[88:91]
  s_waitcnt lgkmcnt(9)
  v_mfma_f32_32x32x16_bf16 v[48:63], v[108:111], v[192:195], v[48:63]
  ds_read_b64_tr_b16 v[104:105], v10 offset:512
  ds_read_b64_tr_b16 v[106:107], v10 offset:768
  v_xor_b32 v10, 153600, v8
  v_mfma_f32_16x16x32_bf16 v[92:95], v[28:31], v[108:111], v[92:95]
  s_waitcnt lgkmcnt(8)
  v_mfma_f32_32x32x16_bf16 v[32:47], v[112:115], v[196:199], v[32:47]
  ds_read_b64_tr_b16 v[108:109], v10 offset:0
  ds_read_b64_tr_b16 v[110:111], v10 offset:256
  v_bfe_u32 v122, v0, 2, 3
  v_mul_u32_u24 v122, 1024, v122
  v_lshrrev_b32 v123, 5, v0
  v_lshl_add_u32 v122, v123, 6, v122
  v_and_b32 v123, 3, v0
  s_add_u32 m0, s49, 122880
  s_nop 0
  buffer_load_dwordx4 v3, s[24:27], s84 offen lds
  s_waitcnt lgkmcnt(7)
  v_mfma_f32_32x32x16_bf16 v[48:63], v[96:99], v[196:199], v[48:63]
  ds_read_b64_tr_b16 v[112:113], v10 offset:512
  ds_read_b64_tr_b16 v[114:115], v10 offset:768
  v_lshl_add_u32 v122, v123, 4, v122
  v_add_u32 v6, s53, v122
  v_add_u32 v7, 8192, v6
  v_xor_b32 v10, 81920, v8
  s_waitcnt vmcnt(10) lgkmcnt(8)
  s_barrier
  s_waitcnt lgkmcnt(6)
  v_mfma_f32_32x32x16_bf16 v[32:47], v[100:103], v[200:203], v[32:47]
  ds_read_b64_tr_b16 v[96:97], v10 offset:0
  ds_read_b64_tr_b16 v[98:99], v10 offset:256
  ds_read_b128 v[208:211], v84 offset:16384
  v_add_u32 v2, 2048, v2
  v_add_u32 v3, 2048, v3
  s_lshr_b32 s97, s52, 2
  s_add_u32 s97, s97, s52
  s_and_b32 s97, s97, 3
  s_add_u32 m0, s50, 16384
  s_nop 0
  buffer_load_dwordx4 v4, s[8:11], s93 offen lds
  s_waitcnt lgkmcnt(7)
  v_mfma_f32_32x32x16_bf16 v[48:63], v[104:107], v[200:203], v[48:63]
  ds_read_b64_tr_b16 v[100:101], v10 offset:512
  ds_read_b64_tr_b16 v[102:103], v10 offset:768
  ds_read_b128 v[212:215], v85 offset:16384
  s_lshl_b32 s91, s97, 17
  s_and_b32 s92, s91, 0x20000
  s_lshl_b32 s97, s97, 13
  s_xor_b32 s98, s97, 0
  s_add_u32 s85, s98, s62
  s_xor_b32 s98, s97, 8192
  v_xor_b32 v10, 83968, v8
  s_waitcnt lgkmcnt(8)
  v_mfma_f32_32x32x16_bf16 v[32:47], v[108:111], v[204:207], v[32:47]
  ds_read_b64_tr_b16 v[104:105], v10 offset:0
  ds_read_b64_tr_b16 v[106:107], v10 offset:256
  ds_read_b128 v[216:219], v86 offset:16384
  s_add_u32 s86, s98, s62
  s_xor_b32 s98, s97, 16384
  s_add_u32 s87, s98, s62
  s_xor_b32 s98, s97, 24576
  s_add_u32 s88, s98, s62
  s_and_b32 s97, s97, 0x2000
  s_add_u32 m0, s50, 17408
  s_nop 0
  buffer_load_dwordx4 v5, s[8:11], s93 offen lds
  s_waitcnt lgkmcnt(9)
  v_mfma_f32_32x32x16_bf16 v[48:63], v[112:115], v[204:207], v[48:63]
  ds_read_b64_tr_b16 v[108:109], v10 offset:512
  ds_read_b64_tr_b16 v[110:111], v10 offset:768
  ds_read_b128 v[220:223], v87 offset:16384
  s_xor_b32 s98, s97, 0
  s_add_u32 s89, s98, s62
  s_xor_b32 s98, s97, 8192
  s_add_u32 s90, s98, s62
  v_xor_b32 v10, 86016, v8
  s_waitcnt lgkmcnt(9)
  v_mfma_f32_32x32x16_bf16 v[32:47], v[96:99], v[208:211], v[32:47]
  ds_read_b64_tr_b16 v[112:113], v10 offset:0
  ds_read_b64_tr_b16 v[114:115], v10 offset:256
  s_add_u32 m0, s50, 131072
  s_nop 0
  buffer_load_dwordx4 v4, s[8:11], s94 offen lds
  v_mfma_f32_16x16x32_bf16 v[88:91], v[28:31], v[96:99], v[88:91]
  s_waitcnt lgkmcnt(9)
  v_mfma_f32_32x32x16_bf16 v[48:63], v[100:103], v[208:211], v[48:63]
  ds_read_b64_tr_b16 v[96:97], v10 offset:512
  ds_read_b64_tr_b16 v[98:99], v10 offset:768
  v_and_b32 v70, 31, v0
  v_lshlrev_b32 v70, 4, v70
  s_lshl_b32 s74, s47, 2
  s_add_u32 s74, s74, s45
  s_lshl_b32 s74, s74, 9
  s_add_u32 s74, s74, 10003456
  v_xor_b32 v10, 88064, v8
  v_mfma_f32_16x16x32_bf16 v[92:95], v[28:31], v[100:103], v[92:95]
  s_waitcnt lgkmcnt(8)
  v_mfma_f32_32x32x16_bf16 v[32:47], v[104:107], v[212:215], v[32:47]
  ds_read_b64_tr_b16 v[100:101], v10 offset:0
  ds_read_b64_tr_b16 v[102:103], v10 offset:256
  buffer_load_dwordx4 v[64:67], v70, s[40:43], s74 offen sc1
  v_mov_b32 v68, 0
  ds_read_b64 v[68:69], v68 offset:4160
  s_add_u32 m0, s50, 132096
  s_nop 0
  buffer_load_dwordx4 v5, s[8:11], s94 offen lds
  s_waitcnt lgkmcnt(8)
  v_mfma_f32_32x32x16_bf16 v[48:63], v[108:111], v[212:215], v[48:63]
  ds_read_b64_tr_b16 v[104:105], v10 offset:512
  ds_read_b64_tr_b16 v[106:107], v10 offset:768
  v_xor_b32 v10, 98304, v8
  s_waitcnt vmcnt(11) lgkmcnt(9)
  s_barrier
  s_waitcnt lgkmcnt(7)
  v_mfma_f32_32x32x16_bf16 v[32:47], v[112:115], v[216:219], v[32:47]
  ds_read_b64_tr_b16 v[108:109], v10 offset:0
  ds_read_b64_tr_b16 v[110:111], v10 offset:256
  ds_read_b128 v[224:227], v84 offset:32768
  s_add_u32 m0, s50, 32768
  s_nop 0
  buffer_load_dwordx4 v4, s[8:11], s95 offen lds
  s_waitcnt lgkmcnt(8)
  v_mfma_f32_32x32x16_bf16 v[48:63], v[96:99], v[216:219], v[48:63]
  ds_read_b64_tr_b16 v[112:113], v10 offset:512
  ds_read_b64_tr_b16 v[114:115], v10 offset:768
  ds_read_b128 v[228:231], v85 offset:32768
  v_xor_b32 v10, 100352, v8
  s_waitcnt lgkmcnt(9)
  v_mfma_f32_32x32x16_bf16 v[32:47], v[100:103], v[220:223], v[32:47]
  ds_read_b64_tr_b16 v[96:97], v10 offset:0
  ds_read_b64_tr_b16 v[98:99], v10 offset:256
  ds_read_b128 v[232:235], v86 offset:32768
  s_add_u32 m0, s50, 33792
  s_nop 0
  buffer_load_dwordx4 v5, s[8:11], s95 offen lds
  s_waitcnt lgkmcnt(9)
  v_mfma_f32_32x32x16_bf16 v[48:63], v[104:107], v[220:223], v[48:63]
  ds_read_b64_tr_b16 v[100:101], v10 offset:512
  ds_read_b64_tr_b16 v[102:103], v10 offset:768
  ds_read_b128 v[236:239], v87 offset:32768
  v_xor_b32 v10, 102400, v8
  s_waitcnt lgkmcnt(9)
  v_mfma_f32_32x32x16_bf16 v[32:47], v[108:111], v[224:227], v[32:47]
  ds_read_b64_tr_b16 v[104:105], v10 offset:0
  ds_read_b64_tr_b16 v[106:107], v10 offset:256
  s_add_u32 m0, s50, 147456
  s_nop 0
  buffer_load_dwordx4 v4, s[8:11], s96 offen lds
  v_mfma_f32_16x16x32_bf16 v[88:91], v[28:31], v[108:111], v[88:91]
  s_waitcnt lgkmcnt(9)
  v_mfma_f32_32x32x16_bf16 v[48:63], v[112:115], v[224:227], v[48:63]
  ds_read_b64_tr_b16 v[108:109], v10 offset:512
  ds_read_b64_tr_b16 v[110:111], v10 offset:768
  v_xor_b32 v10, 104448, v8
  v_mfma_f32_16x16x32_bf16 v[92:95], v[28:31], v[112:115], v[92:95]
  s_waitcnt lgkmcnt(8)
  v_mfma_f32_32x32x16_bf16 v[32:47], v[96:99], v[228:231], v[32:47]
  ds_read_b64_tr_b16 v[112:113], v10 offset:0
  ds_read_b64_tr_b16 v[114:115], v10 offset:256
  s_add_u32 m0, s50, 148480
  s_nop 0
  buffer_load_dwordx4 v5, s[8:11], s96 offen lds
  s_waitcnt lgkmcnt(7)
  v_mfma_f32_32x32x16_bf16 v[48:63], v[100:103], v[228:231], v[48:63]
  ds_read_b64_tr_b16 v[96:97], v10 offset:512
  ds_read_b64_tr_b16 v[98:99], v10 offset:768
  v_xor_b32 v10, 114688, v8
  s_waitcnt vmcnt(9) lgkmcnt(8)
  s_barrier
  s_waitcnt lgkmcnt(6)
  v_mfma_f32_32x32x16_bf16 v[32:47], v[104:107], v[232:235], v[32:47]
  ds_read_b64_tr_b16 v[100:101], v10 offset:0
  ds_read_b64_tr_b16 v[102:103], v10 offset:256
  ds_read_b128 v[240:243], v84 offset:49152
  s_add_u32 m0, s49, 49152
  s_nop 0
  buffer_load_dwordx4 v2, s[20:23], s77 offen lds
  s_waitcnt lgkmcnt(7)
  v_mfma_f32_32x32x16_bf16 v[48:63], v[108:111], v[232:235], v[48:63]
  ds_read_b64_tr_b16 v[104:105], v10 offset:512
  ds_read_b64_tr_b16 v[106:107], v10 offset:768
  ds_read_b128 v[244:247], v85 offset:49152
  v_xor_b32 v10, 116736, v8
  s_waitcnt lgkmcnt(8)
  v_mfma_f32_32x32x16_bf16 v[32:47], v[112:115], v[236:239], v[32:47]
  ds_read_b64_tr_b16 v[108:109], v10 offset:0
  ds_read_b64_tr_b16 v[110:111], v10 offset:256
  ds_read_b128 v[248:251], v86 offset:49152
  s_add_u32 m0, s49, 57344
  s_nop 0
  buffer_load_dwordx4 v3, s[24:27], s77 offen lds
  s_waitcnt lgkmcnt(9)
  v_mfma_f32_32x32x16_bf16 v[48:63], v[96:99], v[236:239], v[48:63]
  ds_read_b64_tr_b16 v[112:113], v10 offset:512
  ds_read_b64_tr_b16 v[114:115], v10 offset:768
  ds_read_b128 v[252:255], v87 offset:49152
  s_waitcnt vmcnt(7)
  v_cmp_eq_u64 s[68:69], v[66:67], v[68:69]
  v_cmp_ne_u32 s[70:71], 0, v69
  s_nop 1
  s_and_b64 s[68:69], s[68:69], s[70:71]
  s_cmp_eq_u64 s[68:69], -1
  s_cbranch_scc0 OGOK_54
GOK_54:
  v_readfirstlane_b32 s54, v68
  v_readfirstlane_b32 s55, v69
  v_xor_b32 v10, 118784, v8
  s_waitcnt lgkmcnt(10)
  v_mfma_f32_16x16x32_bf16 v[88:91], v[28:31], v[100:103], v[88:91]
  s_waitcnt lgkmcnt(9)
  v_mfma_f32_32x32x16_bf16 v[32:47], v[100:103], v[240:243], v[32:47]
  ds_read_b64_tr_b16 v[96:97], v10 offset:0
  ds_read_b64_tr_b16 v[98:99], v10 offset:256
  v_cvt_pk_bf16_f32 v117, v64, 0
  v_sqrt_f32 v13, v65
  v_lshlrev_b32 v66, 16, v117
  s_add_u32 m0, s49, 81920
  s_nop 0
  buffer_load_dwordx4 v2, s[20:23], s78 offen lds
  s_waitcnt lgkmcnt(9)
  v_mfma_f32_16x16x32_bf16 v[92:95], v[28:31], v[104:107], v[92:95]
  v_mfma_f32_32x32x16_bf16 v[48:63], v[104:107], v[240:243], v[48:63]
  ds_read_b64_tr_b16 v[100:101], v10 offset:512
  ds_read_b64_tr_b16 v[102:103], v10 offset:768
  v_and_b32 v91, 31, v0
  v_lshl_add_u32 v91, v91, 5, s99
  v_cvt_pk_bf16_f32 v88, v90, v90
  v_and_b32 v89, 0xffff0000, v88
  v_sub_f32 v89, v90, v89
  v_xor_b32 v10, 120832, v8
  s_waitcnt lgkmcnt(8)
  v_mfma_f32_32x32x16_bf16 v[32:47], v[108:111], v[244:247], v[32:47]
  ds_read_b64_tr_b16 v[104:105], v10 offset:0
  ds_read_b64_tr_b16 v[106:107], v10 offset:256
  v_cvt_pk_bf16_f32 v89, v89, 0
  ds_write_b64 v91, v[88:89] offset:12288
  v_cvt_pk_bf16_f32 v92, v94, v94
  v_and_b32 v93, 0xffff0000, v92
  v_sub_f32 v93, v94, v93
  s_add_u32 m0, s49, 90112
  s_nop 0
  buffer_load_dwordx4 v3, s[24:27], s78 offen lds
  s_waitcnt lgkmcnt(8)
  v_mfma_f32_32x32x16_bf16 v[48:63], v[112:115], v[244:247], v[48:63]
  ds_read_b64_tr_b16 v[108:109], v10 offset:512
  ds_read_b64_tr_b16 v[110:111], v10 offset:768
  v_cvt_pk_bf16_f32 v93, v93, 0
  ds_write_b64 v91, v[92:93] offset:13312
  v_mov_b32 v24, -1
  v_mov_b32 v25, -1
  v_mov_b32 v26, -1
  v_xor_b32 v10, 16384, v9
  s_waitcnt lgkmcnt(0)
  s_barrier
  v_mfma_f32_32x32x16_bf16 v[32:47], v[96:99], v[248:251], v[32:47]
  ds_read_b64_tr_b16 v[112:113], v10 offset:0
  ds_read_b64_tr_b16 v[114:115], v10 offset:256
  v_and_b32 v91, 31, v0
  v_lshrrev_b32 v90, 5, v0
  v_lshlrev_b32 v91, 5, v91
  v_lshl_add_u32 v91, v90, 4, v91
  s_lshl_b32 s58, s46, 11
  s_add_u32 m0, s49, 65536
  s_nop 0
  buffer_load_dwordx4 v2, s[20:23], s79 offen lds
  v_mfma_f32_32x32x16_bf16 v[48:63], v[100:103], v[248:251], v[48:63]
  ds_read_b64_tr_b16 v[96:97], v10 offset:8192
  ds_read_b64_tr_b16 v[98:99], v10 offset:8448
  v_add_u32 v91, s58, v91
  ds_read_b128 v[92:95], v91 offset:13312
  ds_read_b128 v[88:91], v91 offset:12288
  v_mov_b32 v27, -1
  s_add_u32 s51, s60, 65536
  buffer_store_dwordx4 v[24:27], v1, s[40:43], s51 offen sc1
  v_xor_b32 v10, 18432, v9
  v_mfma_f32_32x32x16_bf16 v[32:47], v[104:107], v[252:255], v[32:47]
  ds_read_b64_tr_b16 v[100:101], v10 offset:0
  ds_read_b64_tr_b16 v[102:103], v10 offset:256
  v_rsq_f32 v15, v65
  v_sub_f32 v66, v64, v66
  v_mov_b32 v119, v117
  v_cvt_pk_bf16_f32 v116, v64, v66
  s_add_u32 m0, s49, 73728
  s_nop 0
  buffer_load_dwordx4 v3, s[24:27], s79 offen lds
  v_mfma_f32_32x32x16_bf16 v[48:63], v[108:111], v[252:255], v[48:63]
  ds_read_b64_tr_b16 v[104:105], v10 offset:8192
  ds_read_b64_tr_b16 v[106:107], v10 offset:8448
  v_mul_f32 v14, 0xbfb8aa3b, v15
  v_mov_b32 v118, v116
  v_mul_f32 v15, 0x3fb8aa3b, v15
  v_xor_b32 v10, 20480, v9
  s_waitcnt lgkmcnt(4)
  v_mfma_f32_32x32x16_bf16 v[32:47], v[88:91], v[116:119], v[32:47]
  v_mfma_f32_32x32x16_bf16 v[48:63], v[92:95], v[116:119], v[48:63]
  v_mfma_f32_32x32x16_bf16 v[64:79], v[112:115], v[128:131], 0
  ds_read_b64_tr_b16 v[108:109], v10 offset:0
  ds_read_b64_tr_b16 v[110:111], v10 offset:256
  s_nop 7
  v_mul_f32 v32, v14, v32
  v_mul_f32 v33, v14, v33
  v_mul_f32 v34, v14, v34
  v_mul_f32 v35, v14, v35
  v_mul_f32 v36, v14, v36
  s_add_u32 m0, s49, 98304
  s_nop 0
  buffer_load_dwordx4 v2, s[20:23], s80 offen lds
  v_mfma_f32_16x16x32_bf16 v[120:123], v[28:31], v[112:115], 0
  v_mfma_f32_32x32x16_bf16 v[64:79], v[96:99], v[144:147], v[64:79]
  ds_read_b64_tr_b16 v[112:113], v10 offset:8192
  ds_read_b64_tr_b16 v[114:115], v10 offset:8448
  s_add_u32 s51, s60, 67584
  buffer_store_dwordx4 v[24:27], v1, s[40:43], s51 offen sc1
  v_mul_f32 v37, v14, v37
  v_mul_f32 v38, v14, v38
  v_mul_f32 v39, v14, v39
  v_xor_b32 v10, 22528, v9
  v_mfma_f32_16x16x32_bf16 v[120:123], v[28:31], v[96:99], v[120:123]
  s_waitcnt lgkmcnt(6)
  v_mfma_f32_32x32x16_bf16 v[64:79], v[100:103], v[132:135], v[64:79]
  ds_read_b64_tr_b16 v[96:97], v10 offset:0
  ds_read_b64_tr_b16 v[98:99], v10 offset:256
  v_exp_f32 v32, v32
  v_exp_f32 v33, v33
  s_add_u32 m0, s49, 106496
  s_nop 0
  buffer_load_dwordx4 v3, s[24:27], s80 offen lds
  s_waitcnt lgkmcnt(6)
  v_mfma_f32_32x32x16_bf16 v[64:79], v[104:107], v[148:151], v[64:79]
  ds_read_b64_tr_b16 v[100:101], v10 offset:8192
  ds_read_b64_tr_b16 v[102:103], v10 offset:8448
  v_exp_f32 v34, v34
  v_exp_f32 v35, v35
  v_xor_b32 v10, 131072, v9
  s_waitcnt vmcnt(14)
  s_barrier
  s_waitcnt lgkmcnt(6)
  v_mfma_f32_32x32x16_bf16 v[64:79], v[108:111], v[136:139], v[64:79]
  ds_read_b64_tr_b16 v[104:105], v10 offset:0
  ds_read_b64_tr_b16 v[106:107], v10 offset:256
  v_exp_f32 v36, v36
  v_exp_f32 v37, v37
  s_add_u32 m0, s49, 114688
  s_nop 0
  buffer_load_dwordx4 v2, s[20:23], s81 offen lds
  s_waitcnt lgkmcnt(6)
  v_mfma_f32_32x32x16_bf16 v[64:79], v[112:115], v[152:155], v[64:79]
  ds_read_b64_tr_b16 v[108:109], v10 offset:8192
  ds_read_b64_tr_b16 v[110:111], v10 offset:8448
  v_exp_f32 v38, v38
  v_exp_f32 v39, v39
  v_fma_f32 v32, v32, v13, v13
  v_xor_b32 v10, 133120, v9
  s_waitcnt lgkmcnt(6)
  v_mfma_f32_32x32x16_bf16 v[64:79], v[96:99], v[140:143], v[64:79]
  ds_read_b64_tr_b16 v[112:113], v10 offset:0
  ds_read_b64_tr_b16 v[114:115], v10 offset:256
  v_fma_f32 v33, v33, v13, v13
  v_fma_f32 v34, v34, v13, v13
  v_fma_f32 v35, v35, v13, v13
  v_fma_f32 v36, v36, v13, v13
  s_add_u32 m0, s49, 122880
  s_nop 0
  buffer_load_dwordx4 v3, s[24:27], s81 offen lds
  s_waitcnt lgkmcnt(6)
  v_mfma_f32_32x32x16_bf16 v[64:79], v[100:103], v[156:159], v[64:79]
  ds_read_b64_tr_b16 v[96:97], v10 offset:8192
  ds_read_b64_tr_b16 v[98:99], v10 offset:8448
  v_fma_f32 v37, v37, v13, v13
  v_fma_f32 v38, v38, v13, v13
  v_fma_f32 v39, v39, v13, v13
  v_xor_b32 v10, 135168, v9
  s_waitcnt lgkmcnt(6)
  v_mfma_f32_32x32x16_bf16 v[64:79], v[104:107], v[160:163], v[64:79]
  ds_read_b64_tr_b16 v[100:101], v10 offset:0
  ds_read_b64_tr_b16 v[102:103], v10 offset:256
  v_rcp_f32 v32, v32
  v_rcp_f32 v33, v33
  v_mfma_f32_16x16x32_bf16 v[120:123], v[28:31], v[104:107], v[120:123]
  s_waitcnt lgkmcnt(6)
  v_mfma_f32_32x32x16_bf16 v[64:79], v[108:111], v[176:179], v[64:79]
  ds_read_b64_tr_b16 v[104:105], v10 offset:8192
  ds_read_b64_tr_b16 v[106:107], v10 offset:8448
  s_add_u32 s51, s61, 114688
  buffer_store_dwordx4 v[24:27], v1, s[40:43], s51 offen sc1
  v_rcp_f32 v34, v34
  v_xor_b32 v10, 137216, v9
  v_mfma_f32_16x16x32_bf16 v[120:123], v[28:31], v[108:111], v[120:123]
  s_waitcnt lgkmcnt(6)
  v_mfma_f32_32x32x16_bf16 v[64:79], v[112:115], v[164:167], v[64:79]
  ds_read_b64_tr_b16 v[108:109], v10 offset:0
  ds_read_b64_tr_b16 v[110:111], v10 offset:256
  v_rcp_f32 v35, v35
  v_rcp_f32 v36, v36
  s_waitcnt lgkmcnt(6)
  v_mfma_f32_32x32x16_bf16 v[64:79], v[96:99], v[180:183], v[64:79]
  ds_read_b64_tr_b16 v[112:113], v10 offset:8192
  ds_read_b64_tr_b16 v[114:115], v10 offset:8448
  v_rcp_f32 v37, v37
  v_rcp_f32 v38, v38
  v_xor_b32 v10, 32768, v9
  s_waitcnt vmcnt(15)
  s_barrier
  s_waitcnt lgkmcnt(6)
  v_mfma_f32_32x32x16_bf16 v[64:79], v[100:103], v[168:171], v[64:79]
  ds_read_b64_tr_b16 v[96:97], v10 offset:0
  ds_read_b64_tr_b16 v[98:99], v10 offset:256
  v_rcp_f32 v39, v39
  v_mul_f32 v32, v32, v40
  v_mul_f32 v33, v33, v41
  v_mul_f32 v34, v34, v42
  s_add_u32 m0, s49, 16384
  s_nop 0
  buffer_load_dwordx4 v2, s[20:23], s82 offen lds
  s_waitcnt lgkmcnt(6)
  v_mfma_f32_32x32x16_bf16 v[64:79], v[104:107], v[184:187], v[64:79]
  ds_read_b64_tr_b16 v[100:101], v10 offset:8192
  ds_read_b64_tr_b16 v[102:103], v10 offset:8448
  v_mul_f32 v35, v35, v43
  v_mul_f32 v36, v36, v44
  v_mul_f32 v37, v37, v45
  v_mul_f32 v38, v38, v46
  v_mul_f32 v39, v39, v47
  s_add_u32 m0, s49, 24576
  v_xor_b32 v10, 34816, v9
  buffer_load_dwordx4 v3, s[24:27], s82 offen lds
  s_waitcnt lgkmcnt(6)
  v_mfma_f32_32x32x16_bf16 v[64:79], v[108:111], v[172:175], v[64:79]
  ds_read_b64_tr_b16 v[104:105], v10 offset:0
  ds_read_b64_tr_b16 v[106:107], v10 offset:256
  v_cvt_pk_bf16_f32 v40, v32, v33
  v_cvt_pk_bf16_f32 v41, v34, v35
  v_cvt_pk_bf16_f32 v42, v36, v37
  v_cvt_pk_bf16_f32 v43, v38, v39
  s_add_u32 s74, s60, 0
  s_waitcnt lgkmcnt(6)
  v_mfma_f32_32x32x16_bf16 v[64:79], v[112:115], v[188:191], v[64:79]
  ds_read_b64_tr_b16 v[108:109], v10 offset:8192
  ds_read_b64_tr_b16 v[110:111], v10 offset:8448
  buffer_store_dwordx4 v[40:43], v1, s[40:43], s74 offen sc1
  v_mul_f32 v48, v14, v48
  v_mul_f32 v49, v14, v49
  v_mul_f32 v50, v14, v50
  v_mul_f32 v51, v14, v51
  v_xor_b32 v10, 36864, v9
  s_waitcnt lgkmcnt(6)
  v_mfma_f32_32x32x16_bf16 v[64:79], v[96:99], v[192:195], v[64:79]
  ds_read_b64_tr_b16 v[112:113], v10 offset:0
  ds_read_b64_tr_b16 v[114:115], v10 offset:256
  v_mul_f32 v52, v14, v52
  v_mul_f32 v53, v14, v53
  v_mul_f32 v54, v14, v54
  v_mul_f32 v55, v14, v55
  v_mfma_f32_16x16x32_bf16 v[120:123], v[28:31], v[96:99], v[120:123]
  s_waitcnt lgkmcnt(6)
  v_mfma_f32_32x32x16_bf16 v[64:79], v[100:103], v[208:211], v[64:79]
  ds_read_b64_tr_b16 v[96:97], v10 offset:8192
  ds_read_b64_tr_b16 v[98:99], v10 offset:8448
  s_add_u32 s51, s61, 115712
  buffer_store_dwordx4 v[24:27], v1, s[40:43], s51 offen sc1
  v_exp_f32 v48, v48
  v_xor_b32 v10, 38912, v9
  v_mfma_f32_16x16x32_bf16 v[120:123], v[28:31], v[100:103], v[120:123]
  s_waitcnt lgkmcnt(6)
  v_mfma_f32_32x32x16_bf16 v[64:79], v[104:107], v[196:199], v[64:79]
  ds_read_b64_tr_b16 v[100:101], v10 offset:0
  ds_read_b64_tr_b16 v[102:103], v10 offset:256
  v_exp_f32 v49, v49
  v_exp_f32 v50, v50
  s_waitcnt lgkmcnt(6)
  v_mfma_f32_32x32x16_bf16 v[64:79], v[108:111], v[212:215], v[64:79]
  ds_read_b64_tr_b16 v[104:105], v10 offset:8192
  ds_read_b64_tr_b16 v[106:107], v10 offset:8448
  v_exp_f32 v51, v51
  v_exp_f32 v52, v52
  v_xor_b32 v10, 147456, v9
  s_waitcnt vmcnt(17)
  s_barrier
  s_waitcnt lgkmcnt(6)
  v_mfma_f32_32x32x16_bf16 v[64:79], v[112:115], v[200:203], v[64:79]
  ds_read_b64_tr_b16 v[108:109], v10 offset:0
  ds_read_b64_tr_b16 v[110:111], v10 offset:256
  v_exp_f32 v53, v53
  v_exp_f32 v54, v54
  s_add_u32 m0, s49, 131072
  s_nop 0
  buffer_load_dwordx4 v2, s[20:23], s83 offen lds
  s_waitcnt lgkmcnt(6)
  v_mfma_f32_32x32x16_bf16 v[64:79], v[96:99], v[216:219], v[64:79]
  ds_read_b64_tr_b16 v[112:113], v10 offset:8192
  ds_read_b64_tr_b16 v[114:115], v10 offset:8448
  v_exp_f32 v55, v55
  v_fma_f32 v48, v48, v13, v13
  v_fma_f32 v49, v49, v13, v13
  s_add_u32 m0, s49, 139264
  v_xor_b32 v10, 149504, v9
  buffer_load_dwordx4 v3, s[24:27], s83 offen lds
  s_waitcnt lgkmcnt(6)
  v_mfma_f32_32x32x16_bf16 v[64:79], v[100:103], v[204:207], v[64:79]
  ds_read_b64_tr_b16 v[96:97], v10 offset:0
  ds_read_b64_tr_b16 v[98:99], v10 offset:256
  v_fma_f32 v50, v50, v13, v13
  v_fma_f32 v51, v51, v13, v13
  v_fma_f32 v52, v52, v13, v13
  v_fma_f32 v53, v53, v13, v13
  s_waitcnt lgkmcnt(6)
  v_mfma_f32_32x32x16_bf16 v[64:79], v[104:107], v[220:223], v[64:79]
  ds_read_b64_tr_b16 v[100:101], v10 offset:8192
  ds_read_b64_tr_b16 v[102:103], v10 offset:8448
  v_fma_f32 v54, v54, v13, v13
  v_fma_f32 v55, v55, v13, v13
  v_rcp_f32 v48, v48
  v_xor_b32 v10, 151552, v9
  s_waitcnt lgkmcnt(6)
  v_mfma_f32_16x16x32_bf16 v[120:123], v[28:31], v[108:111], v[120:123]
  v_mfma_f32_32x32x16_bf16 v[64:79], v[108:111], v[224:227], v[64:79]
  ds_read_b64_tr_b16 v[104:105], v10 offset:0
  ds_read_b64_tr_b16 v[106:107], v10 offset:256
  v_rcp_f32 v49, v49
  v_rcp_f32 v50, v50
  s_waitcnt lgkmcnt(6)
  v_mfma_f32_16x16x32_bf16 v[120:123], v[28:31], v[112:115], v[120:123]
  v_mfma_f32_32x32x16_bf16 v[64:79], v[112:115], v[240:243], v[64:79]
  ds_read_b64_tr_b16 v[108:109], v10 offset:8192
  ds_read_b64_tr_b16 v[110:111], v10 offset:8448
  s_nop 4
  v_and_b32 v123, 31, v0
  v_lshl_add_u32 v123, v123, 5, s99
  v_cvt_pk_bf16_f32 v120, v122, v122
  v_and_b32 v121, 0xffff0000, v120
  v_xor_b32 v10, 153600, v9
  s_waitcnt lgkmcnt(6)
  v_mfma_f32_32x32x16_bf16 v[64:79], v[96:99], v[228:231], v[64:79]
  ds_read_b64_tr_b16 v[112:113], v10 offset:0
  ds_read_b64_tr_b16 v[114:115], v10 offset:256
  v_sub_f32 v121, v122, v121
  v_cvt_pk_bf16_f32 v121, v121, 0
  ds_write_b64 v123, v[120:121] offset:12288
  v_rcp_f32 v51, v51
  s_waitcnt lgkmcnt(7)
  v_mfma_f32_32x32x16_bf16 v[64:79], v[100:103], v[244:247], v[64:79]
  ds_read_b64_tr_b16 v[96:97], v10 offset:8192
  ds_read_b64_tr_b16 v[98:99], v10 offset:8448
  v_rcp_f32 v52, v52
  v_rcp_f32 v53, v53
  v_xor_b32 v10, 49152, v8
  s_waitcnt vmcnt(17) lgkmcnt(2)
  s_barrier
  v_mfma_f32_32x32x16_bf16 v[64:79], v[104:107], v[232:235], v[64:79]
  ds_read_b64_tr_b16 v[100:101], v10 offset:0
  ds_read_b64_tr_b16 v[102:103], v10 offset:256
  v_and_b32 v123, 31, v0
  v_lshrrev_b32 v122, 5, v0
  v_lshlrev_b32 v123, 5, v123
  v_lshl_add_u32 v123, v122, 4, v123
  s_lshl_b32 s58, s46, 11
  s_add_u32 m0, s49, 32768
  s_nop 0
  buffer_load_dwordx4 v2, s[20:23], s84 offen lds
  v_mfma_f32_32x32x16_bf16 v[64:79], v[108:111], v[248:251], v[64:79]
  ds_read_b64_tr_b16 v[104:105], v10 offset:512
  ds_read_b64_tr_b16 v[106:107], v10 offset:768
  v_add_u32 v123, s58, v123
  ds_read_b128 v[120:123], v123 offset:12288
  v_rcp_f32 v54, v54
  s_add_u32 m0, s49, 40960
  v_xor_b32 v10, 51200, v8
  buffer_load_dwordx4 v3, s[24:27], s84 offen lds
  v_mfma_f32_32x32x16_bf16 v[64:79], v[112:115], v[236:239], v[64:79]
  ds_read_b64_tr_b16 v[108:109], v10 offset:0
  ds_read_b64_tr_b16 v[110:111], v10 offset:256
  v_rcp_f32 v55, v55
  v_mul_f32 v48, v48, v56
  v_mul_f32 v49, v49, v57
  v_mul_f32 v50, v50, v58
  s_waitcnt lgkmcnt(7)
  v_mfma_f32_32x32x16_bf16 v[64:79], v[96:99], v[252:255], v[64:79]
  ds_read_b64_tr_b16 v[112:113], v10 offset:512
  ds_read_b64_tr_b16 v[114:115], v10 offset:768
  s_waitcnt lgkmcnt(4)
  v_mfma_f32_32x32x16_bf16 v[64:79], v[120:123], v[116:119], v[64:79]
  v_mul_f32 v51, v51, v59
  v_mul_f32 v52, v52, v60
  v_mul_f32 v53, v53, v61
  v_mul_f32 v54, v54, v62
  v_mul_f32 v55, v55, v63
  v_cvt_pk_bf16_f32 v56, v48, v49
  v_cvt_pk_bf16_f32 v57, v50, v51
  v_cvt_pk_bf16_f32 v58, v52, v53
  v_cvt_pk_bf16_f32 v59, v54, v55
  v_xor_b32 v10, 53248, v8
  s_add_u32 s74, s60, 2048
  buffer_store_dwordx4 v[56:59], v1, s[40:43], s74 offen sc1
  v_mfma_f32_32x32x16_bf16 v[32:47], v[100:103], v[128:131], 0
  ds_read_b64_tr_b16 v[96:97], v10 offset:0
  ds_read_b64_tr_b16 v[98:99], v10 offset:256
  v_cvt_pk_bf16_f32 v64, v64, v65
  v_cvt_pk_bf16_f32 v65, v66, v67
  v_cvt_pk_bf16_f32 v66, v68, v69
  v_cvt_pk_bf16_f32 v67, v70, v71
  v_mfma_f32_16x16x32_bf16 v[120:123], v[28:31], v[100:103], 0
  v_mfma_f32_32x32x16_bf16 v[48:63], v[104:107], v[128:131], 0
  ds_read_b64_tr_b16 v[100:101], v10 offset:512
  ds_read_b64_tr_b16 v[102:103], v10 offset:768
  v_cvt_pk_bf16_f32 v68, v72, v73
  v_cvt_pk_bf16_f32 v69, v74, v75
  v_cvt_pk_bf16_f32 v70, v76, v77
  v_cvt_pk_bf16_f32 v71, v78, v79
  ds_read_b64_tr_b16 v[72:73], v17 offset:512
  v_xor_b32 v10, 55296, v8
  v_mfma_f32_16x16x32_bf16 v[124:127], v[28:31], v[104:107], 0
  s_waitcnt lgkmcnt(7)
  v_mfma_f32_32x32x16_bf16 v[32:47], v[108:111], v[132:135], v[32:47]
  ds_read_b64_tr_b16 v[104:105], v10 offset:0
  ds_read_b64_tr_b16 v[106:107], v10 offset:256
  ds_read_b64_tr_b16 v[74:75], v17 offset:768
  ds_read_b64_tr_b16 v[76:77], v17 offset:1024
  ds_read_b64_tr_b16 v[78:79], v17 offset:1280
  s_waitcnt lgkmcnt(10)
  v_mfma_f32_32x32x16_bf16 v[48:63], v[112:115], v[132:135], v[48:63]
  ds_read_b64_tr_b16 v[108:109], v10 offset:512
  ds_read_b64_tr_b16 v[110:111], v10 offset:768
  v_xor_b32 v10, 81920, v8
  s_waitcnt vmcnt(18)
  s_barrier
  s_waitcnt lgkmcnt(10)
  v_mfma_f32_32x32x16_bf16 v[32:47], v[96:99], v[136:139], v[32:47]
  ds_read_b64_tr_b16 v[112:113], v10 offset:0
  ds_read_b64_tr_b16 v[114:115], v10 offset:256
  s_waitcnt lgkmcnt(9)
  v_xor_b32 v72, v18, v72
  v_xor_b32 v73, v18, v73
  s_waitcnt lgkmcnt(6)
  v_xor_b32 v74, v18, v74
  v_xor_b32 v75, v18, v75
  s_waitcnt lgkmcnt(5)
  v_xor_b32 v76, v18, v76
  s_add_u32 m0, s50, 147456
  s_xor_b32 s72, s91, 0
  buffer_load_dwordx4 v6, s[28:31], s72 offen lds
  v_mfma_f32_32x32x16_bf16 v[48:63], v[100:103], v[136:139], v[48:63]
  ds_read_b64_tr_b16 v[96:97], v10 offset:512
  ds_read_b64_tr_b16 v[98:99], v10 offset:768
  v_xor_b32 v77, v18, v77
  s_waitcnt lgkmcnt(6)
  v_xor_b32 v78, v18, v78
  v_xor_b32 v79, v18, v79
  v_mfma_f32_32x32x16_bf16 v[80:95], v[72:75], v[64:67], 0
  s_add_u32 m0, s50, 148480
  v_xor_b32 v10, 83968, v8
  buffer_load_dwordx4 v7, s[28:31], s72 offen lds
  v_mfma_f32_32x32x16_bf16 v[32:47], v[104:107], v[140:143], v[32:47]
  ds_read_b64_tr_b16 v[100:101], v10 offset:0
  ds_read_b64_tr_b16 v[102:103], v10 offset:256
  s_waitcnt lgkmcnt(6)
  v_mfma_f32_32x32x16_bf16 v[48:63], v[108:111], v[140:143], v[48:63]
  ds_read_b64_tr_b16 v[104:105], v10 offset:512
  ds_read_b64_tr_b16 v[106:107], v10 offset:768
  s_nop 1
  v_max3_f32 v19, v80, v81, v82
  v_max3_f32 v20, v83, v84, v85
  v_max3_f32 v19, v19, v86, v87
  v_max3_f32 v20, v20, v88, v89
  v_xor_b32 v10, 86016, v8
  s_waitcnt lgkmcnt(6)
  v_mfma_f32_32x32x16_bf16 v[32:47], v[112:115], v[144:147], v[32:47]
  ds_read_b64_tr_b16 v[108:109], v10 offset:0
  ds_read_b64_tr_b16 v[110:111], v10 offset:256
  v_max3_f32 v19, v19, v90, v91
  v_max3_f32 v20, v20, v92, v93
  v_max3_f32 v19, v19, v94, v95
  v_max_f32 v19, v19, v20
  v_mfma_f32_16x16x32_bf16 v[120:123], v[28:31], v[112:115], v[120:123]
  s_waitcnt lgkmcnt(6)
  v_mfma_f32_32x32x16_bf16 v[48:63], v[96:99], v[144:147], v[48:63]
  ds_read_b64_tr_b16 v[112:113], v10 offset:512
  ds_read_b64_tr_b16 v[114:115], v10 offset:768
  v_mul_f32 v19, v14, v19
  v_fma_f32 v80, v80, v15, v19
  v_fma_f32 v81, v81, v15, v19
  v_fma_f32 v82, v82, v15, v19
  v_xor_b32 v10, 88064, v8
  v_mfma_f32_16x16x32_bf16 v[124:127], v[28:31], v[96:99], v[124:127]
  s_waitcnt lgkmcnt(6)
  v_mfma_f32_32x32x16_bf16 v[32:47], v[100:103], v[148:151], v[32:47]
  ds_read_b64_tr_b16 v[96:97], v10 offset:0
  ds_read_b64_tr_b16 v[98:99], v10 offset:256
  v_fma_f32 v83, v83, v15, v19
  v_fma_f32 v84, v84, v15, v19
  v_fma_f32 v85, v85, v15, v19
  v_fma_f32 v86, v86, v15, v19
  s_waitcnt lgkmcnt(6)
  v_mfma_f32_32x32x16_bf16 v[48:63], v[104:107], v[148:151], v[48:63]
  ds_read_b64_tr_b16 v[100:101], v10 offset:512
  ds_read_b64_tr_b16 v[102:103], v10 offset:768
  v_fma_f32 v87, v87, v15, v19
  v_fma_f32 v88, v88, v15, v19
  v_fma_f32 v89, v89, v15, v19
  v_fma_f32 v90, v90, v15, v19
  v_xor_b32 v10, 65536, v8
  s_waitcnt vmcnt(2)
  s_barrier
  s_cmp_lg_u32 s44, 0
  s_cbranch_scc0 OPUB_62
PUB_62:
  s_waitcnt lgkmcnt(6)
  v_mfma_f32_32x32x16_bf16 v[32:47], v[108:111], v[152:155], v[32:47]
  ds_read_b64_tr_b16 v[104:105], v10 offset:0
  ds_read_b64_tr_b16 v[106:107], v10 offset:256
  v_fma_f32 v91, v91, v15, v19
  v_fma_f32 v92, v92, v15, v19
  v_fma_f32 v93, v93, v15, v19
  v_fma_f32 v94, v94, v15, v19
  s_add_u32 m0, s50, 49152
  s_xor_b32 s72, s91, 131072
  buffer_load_dwordx4 v6, s[28:31], s72 offen lds
  s_waitcnt lgkmcnt(6)
  v_mfma_f32_32x32x16_bf16 v[48:63], v[112:115], v[152:155], v[48:63]
  ds_read_b64_tr_b16 v[108:109], v10 offset:512
  ds_read_b64_tr_b16 v[110:111], v10 offset:768
  v_fma_f32 v95, v95, v15, v19
  v_exp_f32 v80, v80
  v_exp_f32 v81, v81
  s_add_u32 m0, s50, 50176
  v_xor_b32 v10, 67584, v8
  buffer_load_dwordx4 v7, s[28:31], s72 offen lds
  s_waitcnt lgkmcnt(6)
  v_mfma_f32_32x32x16_bf16 v[32:47], v[96:99], v[156:159], v[32:47]
  ds_read_b64_tr_b16 v[112:113], v10 offset:0
  ds_read_b64_tr_b16 v[114:115], v10 offset:256
  v_exp_f32 v82, v82
  v_exp_f32 v83, v83
  s_waitcnt lgkmcnt(6)
  v_mfma_f32_32x32x16_bf16 v[48:63], v[100:103], v[156:159], v[48:63]
  ds_read_b64_tr_b16 v[96:97], v10 offset:512
  ds_read_b64_tr_b16 v[98:99], v10 offset:768
  v_exp_f32 v84, v84
  v_exp_f32 v85, v85
  v_xor_b32 v10, 69632, v8
  s_waitcnt lgkmcnt(6)
  v_mfma_f32_32x32x16_bf16 v[32:47], v[104:107], v[160:163], v[32:47]
  ds_read_b64_tr_b16 v[100:101], v10 offset:0
  ds_read_b64_tr_b16 v[102:103], v10 offset:256
  v_exp_f32 v86, v86
  v_exp_f32 v87, v87
  v_mfma_f32_16x16x32_bf16 v[120:123], v[28:31], v[104:107], v[120:123]
  s_waitcnt lgkmcnt(6)
  v_mfma_f32_32x32x16_bf16 v[48:63], v[108:111], v[160:163], v[48:63]
  ds_read_b64_tr_b16 v[104:105], v10 offset:512
  ds_read_b64_tr_b16 v[106:107], v10 offset:768
  v_exp_f32 v88, v88
  v_exp_f32 v89, v89
  v_xor_b32 v10, 71680, v8
  v_mfma_f32_16x16x32_bf16 v[124:127], v[28:31], v[108:111], v[124:127]
  s_waitcnt lgkmcnt(6)
  v_mfma_f32_32x32x16_bf16 v[32:47], v[112:115], v[164:167], v[32:47]
  ds_read_b64_tr_b16 v[108:109], v10 offset:0
  ds_read_b64_tr_b16 v[110:111], v10 offset:256
  v_exp_f32 v90, v90
  v_exp_f32 v91, v91
  s_waitcnt lgkmcnt(6)
  v_mfma_f32_32x32x16_bf16 v[48:63], v[96:99], v[164:167], v[48:63]
  ds_read_b64_tr_b16 v[112:113], v10 offset:512
  ds_read_b64_tr_b16 v[114:115], v10 offset:768
  v_exp_f32 v92, v92
  v_exp_f32 v93, v93
  v_xor_b32 v10, 98304, v8
  s_barrier
  s_waitcnt lgkmcnt(6)
  v_mfma_f32_32x32x16_bf16 v[32:47], v[100:103], v[168:171], v[32:47]
  ds_read_b64_tr_b16 v[96:97], v10 offset:0
  ds_read_b64_tr_b16 v[98:99], v10 offset:256
  v_exp_f32 v94, v94
  v_exp_f32 v95, v95
  v_add_f32 v19, v80, v81
  s_add_u32 m0, s50, 81920
  s_xor_b32 s72, s91, 262144
  buffer_load_dwordx4 v6, s[28:31], s72 offen lds
  s_waitcnt lgkmcnt(6)
  v_mfma_f32_32x32x16_bf16 v[48:63], v[104:107], v[168:171], v[48:63]
  ds_read_b64_tr_b16 v[100:101], v10 offset:512
  ds_read_b64_tr_b16 v[102:103], v10 offset:768
  v_add_f32 v20, v82, v83
  v_add_f32 v19, v19, v84
  v_add_f32 v20, v20, v85
  v_add_f32 v19, v19, v86
  v_add_f32 v20, v20, v87
  s_add_u32 m0, s50, 82944
  v_xor_b32 v10, 100352, v8
  buffer_load_dwordx4 v7, s[28:31], s72 offen lds
  s_waitcnt lgkmcnt(6)
  v_mfma_f32_32x32x16_bf16 v[32:47], v[108:111], v[172:175], v[32:47]
  ds_read_b64_tr_b16 v[104:105], v10 offset:0
  ds_read_b64_tr_b16 v[106:107], v10 offset:256
  v_add_f32 v19, v19, v88
  v_add_f32 v20, v20, v89
  v_add_f32 v19, v19, v90
  v_add_f32 v20, v20, v91
  v_add_f32 v19, v19, v92
  s_waitcnt lgkmcnt(6)
  v_mfma_f32_32x32x16_bf16 v[48:63], v[112:115], v[172:175], v[48:63]
  ds_read_b64_tr_b16 v[108:109], v10 offset:512
  ds_read_b64_tr_b16 v[110:111], v10 offset:768
  v_min_u32 v23, 7, v0
  s_add_u32 s97, s76, 9994624
  v_lshl_add_u32 v23, v23, 3, s97
  buffer_load_dwordx2 v[24:25], v23, s[40:43], s3 offen sc1
  v_add_f32 v20, v20, v93
  v_xor_b32 v10, 102400, v8
  s_waitcnt lgkmcnt(6)
  v_mfma_f32_32x32x16_bf16 v[32:47], v[96:99], v[176:179], v[32:47]
  ds_read_b64_tr_b16 v[112:113], v10 offset:0
  ds_read_b64_tr_b16 v[114:115], v10 offset:256
  v_add_f32 v19, v19, v94
  v_add_f32 v20, v20, v95
  v_add_f32 v19, v19, v20
  v_rcp_f32 v19, v19
  v_mfma_f32_16x16x32_bf16 v[120:123], v[28:31], v[96:99], v[120:123]
  s_waitcnt lgkmcnt(6)
  v_mfma_f32_32x32x16_bf16 v[48:63], v[100:103], v[176:179], v[48:63]
  ds_read_b64_tr_b16 v[96:97], v10 offset:512
  ds_read_b64_tr_b16 v[98:99], v10 offset:768
  v_mul_f32 v80, v19, v80
  v_mul_f32 v81, v19, v81
  v_mul_f32 v82, v19, v82
  v_mul_f32 v83, v19, v83
  v_mul_f32 v84, v19, v84
  v_xor_b32 v10, 104448, v8
  v_mfma_f32_16x16x32_bf16 v[124:127], v[28:31], v[100:103], v[124:127]
  s_waitcnt lgkmcnt(6)
  v_mfma_f32_32x32x16_bf16 v[32:47], v[104:107], v[180:183], v[32:47]
  ds_read_b64_tr_b16 v[100:101], v10 offset:0
  ds_read_b64_tr_b16 v[102:103], v10 offset:256
  v_mul_f32 v85, v19, v85
  v_mul_f32 v86, v19, v86
  v_mul_f32 v87, v19, v87
  v_mul_f32 v88, v19, v88
  v_mul_f32 v89, v19, v89
  s_waitcnt lgkmcnt(6)
  v_mfma_f32_32x32x16_bf16 v[48:63], v[108:111], v[180:183], v[48:63]
  ds_read_b64_tr_b16 v[104:105], v10 offset:512
  ds_read_b64_tr_b16 v[106:107], v10 offset:768
  v_mul_f32 v90, v19, v90
  v_mul_f32 v91, v19, v91
  v_mul_f32 v92, v19, v92
  v_mul_f32 v93, v19, v93
  v_mul_f32 v94, v19, v94
  v_xor_b32 v10, 114688, v8
  s_barrier
  s_waitcnt lgkmcnt(6)
  v_mfma_f32_32x32x16_bf16 v[32:47], v[112:115], v[184:187], v[32:47]
  ds_read_b64_tr_b16 v[108:109], v10 offset:0
  ds_read_b64_tr_b16 v[110:111], v10 offset:256
  v_mul_f32 v95, v19, v95
  v_cvt_pk_bf16_f32 v64, v80, v81
  v_cvt_pk_bf16_f32 v65, v82, v83
  v_cvt_pk_bf16_f32 v66, v84, v85
  v_cvt_pk_bf16_f32 v67, v86, v87
  s_add_u32 m0, s50, 65536
  s_xor_b32 s72, s91, 393216
  buffer_load_dwordx4 v6, s[28:31], s72 offen lds
  s_waitcnt lgkmcnt(6)
  v_mfma_f32_32x32x16_bf16 v[48:63], v[96:99], v[184:187], v[48:63]
  ds_read_b64_tr_b16 v[112:113], v10 offset:512
  ds_read_b64_tr_b16 v[114:115], v10 offset:768
  v_cvt_pk_bf16_f32 v72, v88, v89
  v_cvt_pk_bf16_f32 v73, v90, v91
  v_cvt_pk_bf16_f32 v74, v92, v93
  v_cvt_pk_bf16_f32 v75, v94, v95
  v_mfma_f32_32x32x16_bf16 v[80:95], v[76:79], v[68:71], 0
  s_add_u32 m0, s50, 66560
  v_xor_b32 v10, 116736, v8
  buffer_load_dwordx4 v7, s[28:31], s72 offen lds
  s_waitcnt lgkmcnt(6)
  v_mfma_f32_32x32x16_bf16 v[32:47], v[100:103], v[188:191], v[32:47]
  ds_read_b64_tr_b16 v[96:97], v10 offset:0
  ds_read_b64_tr_b16 v[98:99], v10 offset:256
  s_waitcnt lgkmcnt(6)
  v_mfma_f32_32x32x16_bf16 v[48:63], v[104:107], v[188:191], v[48:63]
  ds_read_b64_tr_b16 v[100:101], v10 offset:512
  ds_read_b64_tr_b16 v[102:103], v10 offset:768
  s_nop 0
  v_max3_f32 v19, v80, v81, v82
  v_max3_f32 v20, v83, v84, v85
  v_max3_f32 v19, v19, v86, v87
  v_max3_f32 v20, v20, v88, v89
  v_xor_b32 v10, 118784, v8
  s_waitcnt lgkmcnt(6)
  v_mfma_f32_32x32x16_bf16 v[32:47], v[108:111], v[192:195], v[32:47]
  ds_read_b64_tr_b16 v[104:105], v10 offset:0
  ds_read_b64_tr_b16 v[106:107], v10 offset:256
  v_max3_f32 v19, v19, v90, v91
  v_max3_f32 v20, v20, v92, v93
  v_max3_f32 v19, v19, v94, v95
  v_max_f32 v19, v19, v20
  v_mfma_f32_16x16x32_bf16 v[120:123], v[28:31], v[108:111], v[120:123]
  s_waitcnt lgkmcnt(6)
  v_mfma_f32_32x32x16_bf16 v[48:63], v[112:115], v[192:195], v[48:63]
  ds_read_b64_tr_b16 v[108:109], v10 offset:512
  ds_read_b64_tr_b16 v[110:111], v10 offset:768
  v_mul_f32 v19, v14, v19
  v_fma_f32 v80, v80, v15, v19
  v_fma_f32 v81, v81, v15, v19
  v_fma_f32 v82, v82, v15, v19
  v_xor_b32 v10, 120832, v8
  v_mfma_f32_16x16x32_bf16 v[124:127], v[28:31], v[112:115], v[124:127]
  s_waitcnt lgkmcnt(6)
  v_mfma_f32_32x32x16_bf16 v[32:47], v[96:99], v[196:199], v[32:47]
  ds_read_b64_tr_b16 v[112:113], v10 offset:0
  ds_read_b64_tr_b16 v[114:115], v10 offset:256
  v_fma_f32 v83, v83, v15, v19
  v_fma_f32 v84, v84, v15, v19
  v_fma_f32 v85, v85, v15, v19
  v_fma_f32 v86, v86, v15, v19
  s_waitcnt lgkmcnt(6)
  v_mfma_f32_32x32x16_bf16 v[48:63], v[100:103], v[196:199], v[48:63]
  ds_read_b64_tr_b16 v[96:97], v10 offset:512
  ds_read_b64_tr_b16 v[98:99], v10 offset:768
  v_fma_f32 v87, v87, v15, v19
  v_fma_f32 v88, v88, v15, v19
  v_fma_f32 v89, v89, v15, v19
  v_fma_f32 v90, v90, v15, v19
  v_xor_b32 v10, 16384, v8
  s_cmp_lg_u32 s44, 0
  s_cbranch_scc0 OPOK_56
POK_56:
  s_barrier
  s_waitcnt lgkmcnt(6)
  v_mfma_f32_32x32x16_bf16 v[32:47], v[104:107], v[200:203], v[32:47]
  ds_read_b64_tr_b16 v[100:101], v10 offset:0
  ds_read_b64_tr_b16 v[102:103], v10 offset:256
  v_and_b32 v23, 15, v0
  s_lshl_b32 s97, s48, 7
  s_add_u32 s97, s97, 10002432
  v_lshl_add_u32 v23, v23, 3, s97
  s_waitcnt vmcnt(2)
  v_and_b32 v24, 7, v0
  s_add_u32 m0, s50, 98304
  s_xor_b32 s72, s91, 524288
  buffer_load_dwordx4 v6, s[28:31], s72 offen lds
  s_waitcnt lgkmcnt(6)
  v_mfma_f32_32x32x16_bf16 v[48:63], v[108:111], v[200:203], v[48:63]
  ds_read_b64_tr_b16 v[104:105], v10 offset:512
  ds_read_b64_tr_b16 v[106:107], v10 offset:768
  s_add_u32 s97, s76, 9994688
  s_mov_b32 exec_lo, 0
  s_nop 0
  v_lshl_add_u32 v23, v24, 3, s97
  s_mov_b32 exec_lo, -1
  buffer_load_dwordx2 v[24:25], v23, s[40:43], s3 offen sc1
  s_add_u32 m0, s50, 99328
  v_xor_b32 v10, 18432, v8
  buffer_load_dwordx4 v7, s[28:31], s72 offen lds
  s_waitcnt lgkmcnt(6)
  v_mfma_f32_32x32x16_bf16 v[32:47], v[112:115], v[204:207], v[32:47]
  ds_read_b64_tr_b16 v[108:109], v10 offset:0
  ds_read_b64_tr_b16 v[110:111], v10 offset:256
  s_add_u32 s97, s85, 0
  buffer_load_dwordx4 v[128:131], v1, s[40:43], s97 offen offset:0 sc1
  v_fma_f32 v91, v91, v15, v19
  v_fma_f32 v92, v92, v15, v19
  v_fma_f32 v93, v93, v15, v19
  v_fma_f32 v94, v94, v15, v19
  s_waitcnt lgkmcnt(6)
  v_mfma_f32_32x32x16_bf16 v[48:63], v[96:99], v[204:207], v[48:63]
  ds_read_b64_tr_b16 v[112:113], v10 offset:512
  ds_read_b64_tr_b16 v[114:115], v10 offset:768
  v_and_b32 v204, 1, v0
  v_lshlrev_b32 v204, 4, v204
  v_mov_b32 v205, 0x3f80
  v_lshlrev_b32 v204, v204, v205
  v_bfe_u32 v205, v0, 1, 3
  v_xor_b32 v10, 20480, v8
  s_waitcnt lgkmcnt(6)
  v_mfma_f32_32x32x16_bf16 v[32:47], v[100:103], v[208:211], v[32:47]
  ds_read_b64_tr_b16 v[96:97], v10 offset:0
  ds_read_b64_tr_b16 v[98:99], v10 offset:256
  v_cmp_eq_u32 vcc, 0, v205
  s_nop 1
  v_cndmask_b32 v192, 0, v204, vcc
  v_cmp_eq_u32 vcc, 1, v205
  s_nop 1
  v_cndmask_b32 v193, 0, v204, vcc
  v_cmp_eq_u32 vcc, 2, v205
  s_add_u32 s97, s85, 0
  buffer_load_dwordx4 v[132:135], v1, s[40:43], s97 offen offset:1024 sc1
  v_mfma_f32_16x16x32_bf16 v[120:123], v[28:31], v[100:103], v[120:123]
  s_waitcnt lgkmcnt(6)
  v_mfma_f32_32x32x16_bf16 v[48:63], v[104:107], v[208:211], v[48:63]
  ds_read_b64_tr_b16 v[100:101], v10 offset:512
  ds_read_b64_tr_b16 v[102:103], v10 offset:768
  v_cndmask_b32 v194, 0, v204, vcc
  v_cmp_eq_u32 vcc, 3, v205
  s_nop 1
  v_cndmask_b32 v195, 0, v204, vcc
  v_cmp_eq_u32 vcc, 4, v205
  s_nop 1
  v_cndmask_b32 v196, 0, v204, vcc
  v_xor_b32 v10, 22528, v8
  v_mfma_f32_16x16x32_bf16 v[124:127], v[28:31], v[104:107], v[124:127]
  s_waitcnt lgkmcnt(6)
  v_mfma_f32_32x32x16_bf16 v[32:47], v[108:111], v[212:215], v[32:47]
  ds_read_b64_tr_b16 v[104:105], v10 offset:0
  ds_read_b64_tr_b16 v[106:107], v10 offset:256
  v_cmp_eq_u32 vcc, 5, v205
  s_nop 1
  v_cndmask_b32 v197, 0, v204, vcc
  v_cmp_eq_u32 vcc, 6, v205
  s_nop 1
  v_cndmask_b32 v198, 0, v204, vcc
  v_cmp_eq_u32 vcc, 7, v205
  s_add_u32 s97, s86, 0
  buffer_load_dwordx4 v[136:139], v1, s[40:43], s97 offen offset:0 sc1
  s_add_u32 s97, s86, 0
  buffer_load_dwordx4 v[140:143], v1, s[40:43], s97 offen offset:1024 sc1
  s_waitcnt lgkmcnt(6)
  v_mfma_f32_32x32x16_bf16 v[48:63], v[112:115], v[212:215], v[48:63]
  ds_read_b64_tr_b16 v[108:109], v10 offset:512
  ds_read_b64_tr_b16 v[110:111], v10 offset:768
  v_cndmask_b32 v199, 0, v204, vcc
  v_lshrrev_b32 v204, 4, v0
  v_and_b32 v200, 0xf0, v1
  v_min_u32 v201, 16, v200
  v_lshl_add_u32 v200, v204, 9, v200
  v_xor_b32 v10, 131072, v8
  s_cmp_lg_u32 s44, 0
  s_cbranch_scc0 OPOK_58
POK_58:
  s_barrier
  s_waitcnt lgkmcnt(6)
  v_mfma_f32_32x32x16_bf16 v[32:47], v[96:99], v[216:219], v[32:47]
  ds_read_b64_tr_b16 v[112:113], v10 offset:0
  ds_read_b64_tr_b16 v[114:115], v10 offset:256
  s_lshr_b32 s56, s44, 1
  s_lshl_b32 s56, s56, 11
  s_and_b32 s57, s44, 1
  s_lshl_b32 s57, s57, 5
  s_add_u32 s56, s56, s57
  v_and_b32 v203, 1, v204
  s_add_u32 s97, s87, 0
  buffer_load_dwordx4 v[144:147], v1, s[40:43], s97 offen offset:0 sc1
  s_waitcnt lgkmcnt(6)
  v_mfma_f32_32x32x16_bf16 v[48:63], v[100:103], v[216:219], v[48:63]
  ds_read_b64_tr_b16 v[96:97], v10 offset:512
  ds_read_b64_tr_b16 v[98:99], v10 offset:768
  v_lshl_add_u32 v203, v203, 3, s56
  v_lshl_add_u32 v202, v205, 6, v203
  v_and_b32 v205, 16, v1
  v_add_u32 v202, v202, v205
  v_xor_b32 v10, 133120, v8
  s_waitcnt lgkmcnt(6)
  v_mfma_f32_32x32x16_bf16 v[32:47], v[104:107], v[220:223], v[32:47]
  ds_read_b64_tr_b16 v[100:101], v10 offset:0
  ds_read_b64_tr_b16 v[102:103], v10 offset:256
  v_and_b32 v205, 0x200, v1
  v_add_u32 v202, v202, v205
  v_add_u32 v203, v203, v201
  v_lshl_add_u32 v201, v204, 5, v201
  s_add_u32 s97, s87, 0
  buffer_load_dwordx4 v[148:151], v1, s[40:43], s97 offen offset:1024 sc1
  s_waitcnt lgkmcnt(6)
  v_mfma_f32_32x32x16_bf16 v[48:63], v[108:111], v[220:223], v[48:63]
  ds_read_b64_tr_b16 v[104:105], v10 offset:512
  ds_read_b64_tr_b16 v[106:107], v10 offset:768
  s_add_u32 s57, s64, 4096
  v_fma_f32 v95, v95, v15, v19
  v_exp_f32 v80, v80
  v_xor_b32 v10, 135168, v8
  s_waitcnt lgkmcnt(6)
  v_mfma_f32_32x32x16_bf16 v[32:47], v[112:115], v[224:227], v[32:47]
  ds_read_b64_tr_b16 v[108:109], v10 offset:0
  ds_read_b64_tr_b16 v[110:111], v10 offset:256
  buffer_load_dwordx4 v[208:211], v200, s[40:43], s64 offen offset:0 sc1
  buffer_load_dwordx4 v[212:215], v200, s[40:43], s64 offen offset:256 sc1
  v_exp_f32 v81, v81
  v_mfma_f32_16x16x32_bf16 v[120:123], v[28:31], v[112:115], v[120:123]
  s_waitcnt lgkmcnt(6)
  v_mfma_f32_32x32x16_bf16 v[48:63], v[96:99], v[224:227], v[48:63]
  ds_read_b64_tr_b16 v[112:113], v10 offset:512
  ds_read_b64_tr_b16 v[114:115], v10 offset:768
  v_exp_f32 v82, v82
  v_exp_f32 v83, v83
  v_xor_b32 v10, 137216, v8
  v_mfma_f32_16x16x32_bf16 v[124:127], v[28:31], v[96:99], v[124:127]
  s_waitcnt lgkmcnt(6)
  v_mfma_f32_32x32x16_bf16 v[32:47], v[100:103], v[228:231], v[32:47]
  ds_read_b64_tr_b16 v[96:97], v10 offset:0
  ds_read_b64_tr_b16 v[98:99], v10 offset:256
  buffer_load_dwordx4 v[216:219], v200, s[40:43], s64 offen offset:2048 sc1
  v_exp_f32 v84, v84
  v_exp_f32 v85, v85
  s_waitcnt lgkmcnt(6)
  v_mfma_f32_32x32x16_bf16 v[48:63], v[104:107], v[228:231], v[48:63]
  ds_read_b64_tr_b16 v[100:101], v10 offset:512
  ds_read_b64_tr_b16 v[102:103], v10 offset:768
  v_exp_f32 v86, v86
  v_exp_f32 v87, v87
  v_xor_b32 v10, 32768, v8
  s_barrier
  s_waitcnt lgkmcnt(6)
  v_mfma_f32_32x32x16_bf16 v[32:47], v[108:111], v[232:235], v[32:47]
  ds_read_b64_tr_b16 v[104:105], v10 offset:0
  ds_read_b64_tr_b16 v[106:107], v10 offset:256
  buffer_load_dwordx4 v[220:223], v200, s[40:43], s64 offen offset:2304 sc1
  v_exp_f32 v88, v88
  v_exp_f32 v89, v89
  s_waitcnt lgkmcnt(6)
  v_mfma_f32_32x32x16_bf16 v[48:63], v[112:115], v[232:235], v[48:63]
  ds_read_b64_tr_b16 v[108:109], v10 offset:512
  ds_read_b64_tr_b16 v[110:111], v10 offset:768
  v_exp_f32 v90, v90
  v_exp_f32 v91, v91
  v_xor_b32 v10, 34816, v8
  s_waitcnt lgkmcnt(6)
  v_mfma_f32_32x32x16_bf16 v[32:47], v[96:99], v[236:239], v[32:47]
  ds_read_b64_tr_b16 v[112:113], v10 offset:0
  ds_read_b64_tr_b16 v[114:115], v10 offset:256
  buffer_load_dwordx4 v[224:227], v200, s[40:43], s57 offen offset:0 sc1
  buffer_load_dwordx4 v[228:231], v200, s[40:43], s57 offen offset:256 sc1
  v_exp_f32 v92, v92
  s_waitcnt lgkmcnt(6)
  v_mfma_f32_32x32x16_bf16 v[48:63], v[100:103], v[236:239], v[48:63]
  ds_read_b64_tr_b16 v[96:97], v10 offset:512
  ds_read_b64_tr_b16 v[98:99], v10 offset:768
  v_exp_f32 v93, v93
  v_exp_f32 v94, v94
  v_xor_b32 v10, 36864, v8
  s_waitcnt lgkmcnt(6)
  v_mfma_f32_16x16x32_bf16 v[120:123], v[28:31], v[104:107], v[120:123]
  v_mfma_f32_32x32x16_bf16 v[32:47], v[104:107], v[240:243], v[32:47]
  ds_read_b64_tr_b16 v[100:101], v10 offset:0
  ds_read_b64_tr_b16 v[102:103], v10 offset:256
  buffer_load_dwordx4 v[232:235], v200, s[40:43], s57 offen offset:2048 sc1
  v_exp_f32 v95, v95
  v_add_f32 v19, v80, v81
  v_add_f32 v20, v82, v83
  s_waitcnt lgkmcnt(6)
  v_mfma_f32_16x16x32_bf16 v[124:127], v[28:31], v[108:111], v[124:127]
  v_mfma_f32_32x32x16_bf16 v[48:63], v[108:111], v[240:243], v[48:63]
  ds_read_b64_tr_b16 v[104:105], v10 offset:512
  ds_read_b64_tr_b16 v[106:107], v10 offset:768
  v_and_b32 v123, 31, v0
  v_lshl_add_u32 v123, v123, 5, s99
  v_cvt_pk_bf16_f32 v120, v122, v122
  v_and_b32 v121, 0xffff0000, v120
  v_xor_b32 v10, 38912, v8
  s_waitcnt lgkmcnt(6)
  v_mfma_f32_32x32x16_bf16 v[32:47], v[112:115], v[244:247], v[32:47]
  ds_read_b64_tr_b16 v[108:109], v10 offset:0
  ds_read_b64_tr_b16 v[110:111], v10 offset:256
  v_sub_f32 v121, v122, v121
  v_cvt_pk_bf16_f32 v121, v121, 0
  ds_write_b64 v123, v[120:121] offset:12288
  v_cvt_pk_bf16_f32 v124, v126, v126
  v_and_b32 v125, 0xffff0000, v124
  s_waitcnt lgkmcnt(7)
  v_mfma_f32_32x32x16_bf16 v[48:63], v[96:99], v[244:247], v[48:63]
  ds_read_b64_tr_b16 v[112:113], v10 offset:512
  ds_read_b64_tr_b16 v[114:115], v10 offset:768
  v_sub_f32 v125, v126, v125
  v_cvt_pk_bf16_f32 v125, v125, 0
  ds_write_b64 v123, v[124:125] offset:13312
  buffer_load_dwordx4 v[236:239], v200, s[40:43], s57 offen offset:2304 sc1
  buffer_load_dwordx4 v[240:243], v201, s[40:43], s65 offen offset:0 sc1
  v_xor_b32 v10, 147456, v11
  s_waitcnt lgkmcnt(0)
  s_barrier
  v_mfma_f32_32x32x16_bf16 v[32:47], v[100:103], v[248:251], v[32:47]
  ds_read_b64_tr_b16 v[96:97], v10 offset:0
  ds_read_b64_tr_b16 v[98:99], v10 offset:1024
  v_and_b32 v123, 31, v0
  v_lshrrev_b32 v122, 5, v0
  v_lshlrev_b32 v123, 5, v123
  v_lshl_add_u32 v123, v122, 4, v123
  s_lshl_b32 s58, s46, 11
  s_add_u32 s97, s88, 0
  buffer_load_dwordx4 v[152:155], v1, s[40:43], s97 offen offset:0 sc1
  s_add_u32 s97, s88, 0
  buffer_load_dwordx4 v[156:159], v1, s[40:43], s97 offen offset:1024 sc1
  v_mfma_f32_32x32x16_bf16 v[48:63], v[104:107], v[248:251], v[48:63]
  ds_read_b64_tr_b16 v[100:101], v10 offset:512
  ds_read_b64_tr_b16 v[102:103], v10 offset:1536
  v_add_u32 v123, s58, v123
  ds_read_b128 v[124:127], v123 offset:13312
  ds_read_b128 v[120:123], v123 offset:12288
  buffer_load_dwordx4 v[244:247], v201, s[40:43], s65 offen offset:128 sc1
  buffer_load_dwordx4 v[248:251], v201, s[40:43], s65 offen offset:256 sc1
  v_mfma_f32_32x32x16_bf16 v[32:47], v[108:111], v[252:255], v[32:47]
  ds_read_b64_tr_b16 v[104:105], v10 offset:2048
  ds_read_b64_tr_b16 v[106:107], v10 offset:3072
  v_add_f32 v19, v19, v84
  v_add_f32 v20, v20, v85
  v_add_f32 v19, v19, v86
  v_add_f32 v20, v20, v87
  v_add_f32 v19, v19, v88
  s_add_u32 m0, s50, 114688
  s_xor_b32 s72, s91, 655360
  buffer_load_dwordx4 v6, s[28:31], s72 offen lds
  v_mfma_f32_32x32x16_bf16 v[48:63], v[112:115], v[252:255], v[48:63]
  ds_read_b64_tr_b16 v[108:109], v10 offset:2560
  ds_read_b64_tr_b16 v[110:111], v10 offset:3584
  s_waitcnt lgkmcnt(4)
  v_mfma_f32_32x32x16_bf16 v[32:47], v[120:123], v[116:119], v[32:47]
  v_mfma_f32_32x32x16_bf16 v[48:63], v[124:127], v[116:119], v[48:63]
  buffer_load_dwordx4 v[252:255], v201, s[40:43], s65 offen offset:384 sc1
  v_add_f32 v20, v20, v89
  v_add_f32 v19, v19, v90
  v_add_f32 v20, v20, v91
  v_add_f32 v19, v19, v92
  v_add_f32 v20, v20, v93
  v_add_f32 v19, v19, v94
  v_add_f32 v20, v20, v95
  v_add_f32 v19, v19, v20
  v_rcp_f32 v19, v19
  s_nop 0
  v_mul_f32 v80, v19, v80
  v_mul_f32 v81, v19, v81
  v_mul_f32 v82, v19, v82
  v_mul_f32 v83, v19, v83
  v_mul_f32 v84, v19, v84
  v_mul_f32 v85, v19, v85
  v_mul_f32 v86, v19, v86
  v_mul_f32 v87, v19, v87
  v_mul_f32 v88, v19, v88
  v_mul_f32 v89, v19, v89
  s_add_u32 s97, s85, 32768
  buffer_load_dwordx4 v[160:163], v1, s[40:43], s97 offen offset:0 sc1
  v_mul_f32 v90, v19, v90
  v_mul_f32 v91, v19, v91
  v_mul_f32 v92, v19, v92
  v_mul_f32 v93, v19, v93
  v_mul_f32 v94, v19, v94
  v_mul_f32 v95, v19, v95
  v_cvt_pk_bf16_f32 v68, v80, v81
  v_cvt_pk_bf16_f32 v69, v82, v83
  v_cvt_pk_bf16_f32 v70, v84, v85
  v_cvt_pk_bf16_f32 v71, v86, v87
  v_cvt_pk_bf16_f32 v76, v88, v89
  v_cvt_pk_bf16_f32 v77, v90, v91
  v_cvt_pk_bf16_f32 v78, v92, v93
  v_cvt_pk_bf16_f32 v79, v94, v95
  v_mul_f32 v32, v14, v32
  v_mul_f32 v33, v14, v33
  v_mul_f32 v34, v14, v34
  v_mul_f32 v35, v14, v35
  v_mul_f32 v36, v14, v36
  v_mul_f32 v37, v14, v37
  s_add_u32 s97, s85, 32768
  buffer_load_dwordx4 v[164:167], v1, s[40:43], s97 offen offset:1024 sc1
  v_mul_f32 v38, v14, v38
  v_mul_f32 v39, v14, v39
  v_exp_f32 v32, v32
  v_exp_f32 v33, v33
  v_exp_f32 v34, v34
  v_exp_f32 v35, v35
  v_exp_f32 v36, v36
  v_exp_f32 v37, v37
  v_exp_f32 v38, v38
  v_exp_f32 v39, v39
  v_fma_f32 v32, v32, v13, v13
  v_fma_f32 v33, v33, v13, v13
  s_add_u32 s97, s86, 32768
  buffer_load_dwordx4 v[168:171], v1, s[40:43], s97 offen offset:0 sc1
  v_fma_f32 v34, v34, v13, v13
  v_fma_f32 v35, v35, v13, v13
  v_fma_f32 v36, v36, v13, v13
  v_fma_f32 v37, v37, v13, v13
  v_fma_f32 v38, v38, v13, v13
  v_fma_f32 v39, v39, v13, v13
  v_rcp_f32 v32, v32
  v_rcp_f32 v33, v33
  v_rcp_f32 v34, v34
  v_rcp_f32 v35, v35
  v_rcp_f32 v36, v36
  v_rcp_f32 v37, v37
  s_add_u32 s97, s86, 32768
  buffer_load_dwordx4 v[172:175], v1, s[40:43], s97 offen offset:1024 sc1
  v_rcp_f32 v38, v38
  v_rcp_f32 v39, v39
  v_mul_f32 v32, v32, v40
  v_mul_f32 v33, v33, v41
  v_mul_f32 v34, v34, v42
  v_mul_f32 v35, v35, v43
  v_mul_f32 v36, v36, v44
  v_mul_f32 v37, v37, v45
  v_mul_f32 v38, v38, v46
  v_mul_f32 v39, v39, v47
  v_cvt_pk_bf16_f32 v40, v32, v33
  v_cvt_pk_bf16_f32 v41, v34, v35
  v_cvt_pk_bf16_f32 v42, v36, v37
  v_cvt_pk_bf16_f32 v43, v38, v39
  s_add_u32 s74, s60, 65536
  buffer_store_dwordx4 v[40:43], v1, s[40:43], s74 offen sc1
  v_mul_f32 v48, v14, v48
  v_mul_f32 v49, v14, v49
  s_add_u32 s97, s87, 32768
  buffer_load_dwordx4 v[176:179], v1, s[40:43], s97 offen offset:0 sc1
  v_mul_f32 v50, v14, v50
  v_mul_f32 v51, v14, v51
  v_mul_f32 v52, v14, v52
  v_mul_f32 v53, v14, v53
  v_mul_f32 v54, v14, v54
  v_mul_f32 v55, v14, v55
  v_exp_f32 v48, v48
  v_exp_f32 v49, v49
  v_exp_f32 v50, v50
  v_exp_f32 v51, v51
  v_exp_f32 v52, v52
  v_exp_f32 v53, v53
  v_exp_f32 v54, v54
  s_add_u32 s97, s87, 32768
  buffer_load_dwordx4 v[180:183], v1, s[40:43], s97 offen offset:1024 sc1
  v_exp_f32 v55, v55
  v_fma_f32 v48, v48, v13, v13
  v_fma_f32 v49, v49, v13, v13
  v_fma_f32 v50, v50, v13, v13
  v_fma_f32 v51, v51, v13, v13
  v_fma_f32 v52, v52, v13, v13
  v_fma_f32 v53, v53, v13, v13
  v_fma_f32 v54, v54, v13, v13
  v_fma_f32 v55, v55, v13, v13
  v_rcp_f32 v48, v48
  v_rcp_f32 v49, v49
  v_rcp_f32 v50, v50
  v_rcp_f32 v51, v51
  s_add_u32 s97, s88, 32768
  buffer_load_dwordx4 v[184:187], v1, s[40:43], s97 offen offset:0 sc1
  v_rcp_f32 v52, v52
  v_rcp_f32 v53, v53
  v_rcp_f32 v54, v54
  v_rcp_f32 v55, v55
  v_mul_f32 v48, v48, v56
  v_mul_f32 v49, v49, v57
  v_mul_f32 v50, v50, v58
  v_mul_f32 v51, v51, v59
  v_mul_f32 v52, v52, v60
  v_mul_f32 v53, v53, v61
  v_mul_f32 v54, v54, v62
  v_mul_f32 v55, v55, v63
  v_cvt_pk_bf16_f32 v56, v48, v49
  v_cvt_pk_bf16_f32 v57, v50, v51
  v_cvt_pk_bf16_f32 v58, v52, v53
  v_cvt_pk_bf16_f32 v59, v54, v55
  s_add_u32 s97, s88, 32768
  buffer_load_dwordx4 v[188:191], v1, s[40:43], s97 offen offset:1024 sc1
  s_add_u32 s74, s60, 67584
  buffer_store_dwordx4 v[56:59], v1, s[40:43], s74 offen sc1
  v_xor_b32 v10, 49152, v11
  s_barrier
  s_waitcnt vmcnt(30)
  v_mfma_f32_32x32x16_bf16 v[32:47], v[96:99], v[128:131], 0
  ds_read_b64_tr_b16 v[112:113], v10 offset:0
  ds_read_b64_tr_b16 v[114:115], v10 offset:1024
  s_waitcnt vmcnt(24)
  v_max3_u32 v204, v208, v209, v210
  s_waitcnt vmcnt(23)
  v_max3_u32 v204, v204, v211, v212
  v_max3_u32 v204, v204, v213, v214
  s_waitcnt vmcnt(22)
  v_max3_u32 v204, v204, v215, v216
  v_max3_u32 v204, v204, v217, v218
  s_waitcnt vmcnt(21)
  v_max3_u32 v204, v204, v219, v220
  v_max3_u32 v204, v204, v221, v222
  s_waitcnt vmcnt(20)
  v_max3_u32 v204, v204, v223, v224
  v_max3_u32 v204, v204, v225, v226
  s_waitcnt vmcnt(19)
  v_max3_u32 v204, v204, v227, v228
  v_max3_u32 v204, v204, v229, v230
  s_waitcnt vmcnt(18)
  v_max3_u32 v204, v204, v231, v232
  v_max3_u32 v204, v204, v233, v234
  s_waitcnt vmcnt(17)
  v_max3_u32 v204, v204, v235, v236
  v_max3_u32 v204, v204, v237, v238
  s_waitcnt vmcnt(16)
  v_max3_u32 v204, v204, v239, v240
  v_max3_u32 v204, v204, v241, v242
  s_waitcnt vmcnt(13)
  v_max3_u32 v204, v204, v243, v244
  v_max3_u32 v204, v204, v245, v246
  s_waitcnt vmcnt(12)
  v_max3_u32 v204, v204, v247, v248
  v_max3_u32 v204, v204, v249, v250
  s_waitcnt vmcnt(10)
  v_max3_u32 v204, v204, v251, v252
  v_max3_u32 v204, v204, v253, v254
  v_max_u32 v204, v204, v255
  v_cmp_eq_u32 vcc, -1, v204
  s_nop 3
  s_cbranch_vccnz OVOK_60
VOK_60:
  v_mfma_f32_16x16x32_bf16 v[204:207], v[192:195], v[208:211], 0
  v_mfma_f32_16x16x32_bf16 v[204:207], v[196:199], v[212:215], v[204:207]
  v_mfma_f32_16x16x32_bf16 v[204:207], v[192:195], v[216:219], v[204:207]
  v_mfma_f32_16x16x32_bf16 v[204:207], v[196:199], v[220:223], v[204:207]
  v_mfma_f32_16x16x32_bf16 v[204:207], v[192:195], v[224:227], v[204:207]
  v_mfma_f32_16x16x32_bf16 v[204:207], v[196:199], v[228:231], v[204:207]
  v_mfma_f32_16x16x32_bf16 v[204:207], v[192:195], v[232:235], v[204:207]
  v_mfma_f32_16x16x32_bf16 v[204:207], v[196:199], v[236:239], v[204:207]
  v_mfma_f32_16x16x32_bf16 v[208:211], v[192:195], v[240:243], 0
  v_mfma_f32_16x16x32_bf16 v[208:211], v[192:195], v[244:247], v[208:211]
  v_mfma_f32_16x16x32_bf16 v[208:211], v[192:195], v[248:251], v[208:211]
  v_mfma_f32_16x16x32_bf16 v[208:211], v[192:195], v[252:255], v[208:211]
  s_nop 3
  v_cvt_pk_bf16_f32 v204, v204, v205
  v_cvt_pk_bf16_f32 v205, v206, v207
  ds_write_b64 v202, v[204:205] offset:4096
  s_nop 0
  v_cvt_pk_bf16_f32 v208, v208, v209
  v_cvt_pk_bf16_f32 v209, v210, v211
  s_mov_b32 exec_hi, 0
  ds_write_b64 v203, v[208:209] offset:5120
  s_mov_b32 exec_hi, -1
  s_add_u32 m0, s50, 115712
  s_nop 0
  buffer_load_dwordx4 v7, s[28:31], s72 offen lds
  v_mfma_f32_32x32x16_bf16 v[48:63], v[100:103], v[128:131], 0
  ds_read_b64_tr_b16 v[96:97], v10 offset:512
  ds_read_b64_tr_b16 v[98:99], v10 offset:1536
  s_add_u32 m0, s50, 16384
  s_xor_b32 s72, s91, 786432
  buffer_load_dwordx4 v6, s[28:31], s72 offen lds
  s_waitcnt lgkmcnt(8)
  v_mfma_f32_32x32x16_bf16 v[32:47], v[104:107], v[132:135], v[32:47]
  ds_read_b64_tr_b16 v[100:101], v10 offset:2048
  ds_read_b64_tr_b16 v[102:103], v10 offset:3072
  s_add_u32 m0, s50, 17408
  s_nop 0
  buffer_load_dwordx4 v7, s[28:31], s72 offen lds
  s_waitcnt lgkmcnt(8)
  v_mfma_f32_32x32x16_bf16 v[48:63], v[108:111], v[132:135], v[48:63]
  ds_read_b64_tr_b16 v[104:105], v10 offset:2560
  ds_read_b64_tr_b16 v[106:107], v10 offset:3584
  v_xor_b32 v10, 81920, v11
  s_waitcnt lgkmcnt(6)
  s_barrier
  v_mfma_f32_32x32x16_bf16 v[32:47], v[112:115], v[136:139], v[32:47]
  ds_read_b64_tr_b16 v[108:109], v10 offset:0
  ds_read_b64_tr_b16 v[110:111], v10 offset:1024
  ds_read_b128 v[120:123], v16 offset:4096
  ds_read_b128 v[124:127], v16 offset:4112
  s_waitcnt lgkmcnt(1)
  v_mfma_f32_32x32x16_bf16 v[80:95], v[120:123], v[64:67], 0
  s_waitcnt lgkmcnt(0)
  v_mfma_f32_32x32x16_bf16 v[80:95], v[124:127], v[72:75], v[80:95]
  s_nop 11
  v_add_f32 v88, 0x358637bd, v88
  v_rcp_f32 v88, v88
  s_nop 0
  v_mul_f32 v80, v88, v80
  v_mul_f32 v81, v88, v81
  v_mul_f32 v82, v88, v82
  v_mul_f32 v83, v88, v83
  v_mul_f32 v84, v88, v84
  v_mul_f32 v85, v88, v85
  v_mul_f32 v86, v88, v86
  v_mul_f32 v87, v88, v87
  v_cvt_pk_bf16_f32 v64, v80, v81
  v_cvt_pk_bf16_f32 v65, v82, v83
  v_cvt_pk_bf16_f32 v66, v84, v85
  v_cvt_pk_bf16_f32 v67, v86, v87
  s_add_u32 s74, s61, 114688
  buffer_store_dwordx4 v[64:67], v1, s[40:43], s74 offen sc1
  ds_read_b128 v[120:123], v16 offset:6144
  ds_read_b128 v[124:127], v16 offset:6160
  s_waitcnt lgkmcnt(1)
  v_mfma_f32_32x32x16_bf16 v[80:95], v[120:123], v[68:71], 0
  s_waitcnt lgkmcnt(0)
  v_mfma_f32_32x32x16_bf16 v[80:95], v[124:127], v[76:79], v[80:95]
  s_nop 11
  v_add_f32 v88, 0x358637bd, v88
  v_rcp_f32 v88, v88
  s_nop 0
  v_mul_f32 v80, v88, v80
  v_mul_f32 v81, v88, v81
  v_mul_f32 v82, v88, v82
  v_mul_f32 v83, v88, v83
  v_mul_f32 v84, v88, v84
  v_mul_f32 v85, v88, v85
  v_mul_f32 v86, v88, v86
  v_mul_f32 v87, v88, v87
  v_cvt_pk_bf16_f32 v68, v80, v81
  v_cvt_pk_bf16_f32 v69, v82, v83
  v_cvt_pk_bf16_f32 v70, v84, v85
  v_cvt_pk_bf16_f32 v71, v86, v87
  s_add_u32 s74, s61, 115712
  buffer_store_dwordx4 v[68:71], v1, s[40:43], s74 offen sc1
  s_add_u32 m0, s50, 131072
  s_xor_b32 s72, s91, 917504
  buffer_load_dwordx4 v6, s[28:31], s72 offen lds
  v_mfma_f32_32x32x16_bf16 v[48:63], v[96:99], v[136:139], v[48:63]
  ds_read_b64_tr_b16 v[112:113], v10 offset:512
  ds_read_b64_tr_b16 v[114:115], v10 offset:1536
  s_add_u32 m0, s50, 132096
  s_nop 0
  buffer_load_dwordx4 v7, s[28:31], s72 offen lds
  v_mfma_f32_32x32x16_bf16 v[32:47], v[100:103], v[140:143], v[32:47]
  ds_read_b64_tr_b16 v[96:97], v10 offset:2048
  ds_read_b64_tr_b16 v[98:99], v10 offset:3072
  s_add_u32 m0, s50, 32768
  s_xor_b32 s72, s91, 1048576
  buffer_load_dwordx4 v6, s[28:31], s72 offen lds
  v_mfma_f32_32x32x16_bf16 v[48:63], v[104:107], v[140:143], v[48:63]
  ds_read_b64_tr_b16 v[100:101], v10 offset:2560
  ds_read_b64_tr_b16 v[102:103], v10 offset:3584
  s_add_u32 m0, s50, 33792
  v_xor_b32 v10, 65536, v11
  buffer_load_dwordx4 v7, s[28:31], s72 offen lds
  s_barrier
  v_mfma_f32_32x32x16_bf16 v[32:47], v[108:111], v[144:147], v[32:47]
  ds_read_b64_tr_b16 v[104:105], v10 offset:0
  ds_read_b64_tr_b16 v[106:107], v10 offset:1024
  s_add_u32 m0, s50, 147456
  s_xor_b32 s72, s91, 1179648
  buffer_load_dwordx4 v6, s[28:31], s72 offen lds
  s_waitcnt lgkmcnt(6)
  v_mfma_f32_32x32x16_bf16 v[48:63], v[112:115], v[144:147], v[48:63]
  ds_read_b64_tr_b16 v[108:109], v10 offset:512
  ds_read_b64_tr_b16 v[110:111], v10 offset:1536
  s_add_u32 m0, s50, 148480
  s_nop 0
  buffer_load_dwordx4 v7, s[28:31], s72 offen lds
  s_waitcnt lgkmcnt(6)
  v_mfma_f32_32x32x16_bf16 v[32:47], v[96:99], v[148:151], v[32:47]
  ds_read_b64_tr_b16 v[112:113], v10 offset:2048
  ds_read_b64_tr_b16 v[114:115], v10 offset:3072
  s_add_u32 m0, s50, 49152
  s_xor_b32 s72, s91, 1310720
  buffer_load_dwordx4 v6, s[28:31], s72 offen lds
  s_waitcnt lgkmcnt(6)
  v_mfma_f32_32x32x16_bf16 v[48:63], v[100:103], v[148:151], v[48:63]
  ds_read_b64_tr_b16 v[96:97], v10 offset:2560
  ds_read_b64_tr_b16 v[98:99], v10 offset:3584
  v_xor_b32 v10, 98304, v11
  s_barrier
  s_waitcnt lgkmcnt(6)
  v_mfma_f32_32x32x16_bf16 v[32:47], v[104:107], v[152:155], v[32:47]
  ds_read_b64_tr_b16 v[100:101], v10 offset:0
  ds_read_b64_tr_b16 v[102:103], v10 offset:1024
  s_add_u32 m0, s50, 50176
  s_nop 0
  buffer_load_dwordx4 v7, s[28:31], s72 offen lds
  s_waitcnt lgkmcnt(6)
  v_mfma_f32_32x32x16_bf16 v[48:63], v[108:111], v[152:155], v[48:63]
  ds_read_b64_tr_b16 v[104:105], v10 offset:512
  ds_read_b64_tr_b16 v[106:107], v10 offset:1536
  s_add_u32 m0, s50, 81920
  s_xor_b32 s72, s91, 1441792
  buffer_load_dwordx4 v6, s[28:31], s72 offen lds
  s_waitcnt lgkmcnt(6)
  v_mfma_f32_32x32x16_bf16 v[32:47], v[112:115], v[156:159], v[32:47]
  ds_read_b64_tr_b16 v[108:109], v10 offset:2048
  ds_read_b64_tr_b16 v[110:111], v10 offset:3072
  s_add_u32 s97, s85, 65536
  buffer_load_dwordx4 v[192:195], v1, s[40:43], s97 offen offset:0 sc1
  s_waitcnt lgkmcnt(6)
  v_mfma_f32_32x32x16_bf16 v[48:63], v[96:99], v[156:159], v[48:63]
  ds_read_b64_tr_b16 v[112:113], v10 offset:2560
  ds_read_b64_tr_b16 v[114:115], v10 offset:3584
  v_xor_b32 v10, 114688, v11
  s_waitcnt vmcnt(14)
  s_barrier
  v_max3_u32 v26, v160, v161, v162
  v_max3_u32 v26, v26, v163, v164
  v_max3_u32 v26, v26, v165, v166
  v_max_u32 v26, v26, v167
  v_cmp_eq_u32 vcc, -1, v26
  s_nop 3
  s_cbranch_vccnz OVOK_63
VOK_63:
  s_waitcnt lgkmcnt(6)
  v_mfma_f32_32x32x16_bf16 v[32:47], v[100:103], v[160:163], v[32:47]
  ds_read_b64_tr_b16 v[96:97], v10 offset:0
  ds_read_b64_tr_b16 v[98:99], v10 offset:1024
  s_add_u32 s97, s85, 65536
  buffer_load_dwordx4 v[196:199], v1, s[40:43], s97 offen offset:1024 sc1
  s_add_u32 s97, s86, 65536
  buffer_load_dwordx4 v[200:203], v1, s[40:43], s97 offen offset:0 sc1
  s_waitcnt lgkmcnt(6)
  v_mfma_f32_32x32x16_bf16 v[48:63], v[104:107], v[160:163], v[48:63]
  ds_read_b64_tr_b16 v[100:101], v10 offset:512
  ds_read_b64_tr_b16 v[102:103], v10 offset:1536
  s_waitcnt lgkmcnt(6)
  v_mfma_f32_32x32x16_bf16 v[32:47], v[108:111], v[164:167], v[32:47]
  ds_read_b64_tr_b16 v[104:105], v10 offset:2048
  ds_read_b64_tr_b16 v[106:107], v10 offset:3072
  s_add_u32 s97, s86, 65536
  buffer_load_dwordx4 v[204:207], v1, s[40:43], s97 offen offset:1024 sc1
  s_add_u32 m0, s50, 82944
  s_nop 0
  buffer_load_dwordx4 v7, s[28:31], s72 offen lds
  s_waitcnt lgkmcnt(6)
  v_mfma_f32_32x32x16_bf16 v[48:63], v[112:115], v[164:167], v[48:63]
  ds_read_b64_tr_b16 v[108:109], v10 offset:2560
  ds_read_b64_tr_b16 v[110:111], v10 offset:3584
  v_xor_b32 v10, 16384, v11
  s_waitcnt vmcnt(16)
  s_barrier
  v_max3_u32 v26, v168, v169, v170
  v_max3_u32 v26, v26, v171, v172
  v_max3_u32 v26, v26, v173, v174
  v_max_u32 v26, v26, v175
  v_cmp_eq_u32 vcc, -1, v26
  s_nop 3
  s_cbranch_vccnz OVOK_65
VOK_65:
  s_waitcnt lgkmcnt(6)
  v_mfma_f32_32x32x16_bf16 v[32:47], v[96:99], v[168:171], v[32:47]
  ds_read_b64_tr_b16 v[112:113], v10 offset:0
  ds_read_b64_tr_b16 v[114:115], v10 offset:1024
  s_add_u32 m0, s50, 65536
  s_xor_b32 s72, s92, 1572864
  buffer_load_dwordx4 v6, s[28:31], s72 offen lds
  s_waitcnt lgkmcnt(6)
  v_mfma_f32_32x32x16_bf16 v[48:63], v[100:103], v[168:171], v[48:63]
  ds_read_b64_tr_b16 v[96:97], v10 offset:512
  ds_read_b64_tr_b16 v[98:99], v10 offset:1536
  s_waitcnt lgkmcnt(6)
  v_mfma_f32_32x32x16_bf16 v[32:47], v[104:107], v[172:175], v[32:47]
  ds_read_b64_tr_b16 v[100:101], v10 offset:2048
  ds_read_b64_tr_b16 v[102:103], v10 offset:3072
  s_add_u32 s97, s87, 65536
  buffer_load_dwordx4 v[208:211], v1, s[40:43], s97 offen offset:0 sc1
  s_add_u32 m0, s50, 66560
  s_nop 0
  buffer_load_dwordx4 v7, s[28:31], s72 offen lds
  s_waitcnt lgkmcnt(6)
  v_mfma_f32_32x32x16_bf16 v[48:63], v[108:111], v[172:175], v[48:63]
  ds_read_b64_tr_b16 v[104:105], v10 offset:2560
  ds_read_b64_tr_b16 v[106:107], v10 offset:3584
  v_xor_b32 v10, 131072, v11
  s_waitcnt vmcnt(15)
  s_barrier
  v_max3_u32 v26, v176, v177, v178
  v_max3_u32 v26, v26, v179, v180
  v_max3_u32 v26, v26, v181, v182
  v_max_u32 v26, v26, v183
  v_cmp_eq_u32 vcc, -1, v26
  s_nop 3
  s_cbranch_vccnz OVOK_67
VOK_67:
  s_waitcnt lgkmcnt(6)
  v_mfma_f32_32x32x16_bf16 v[32:47], v[112:115], v[176:179], v[32:47]
  ds_read_b64_tr_b16 v[108:109], v10 offset:0
  ds_read_b64_tr_b16 v[110:111], v10 offset:1024
  s_add_u32 s97, s87, 65536
  buffer_load_dwordx4 v[212:215], v1, s[40:43], s97 offen offset:1024 sc1
  s_waitcnt lgkmcnt(6)
  v_mfma_f32_32x32x16_bf16 v[48:63], v[96:99], v[176:179], v[48:63]
  ds_read_b64_tr_b16 v[112:113], v10 offset:512
  ds_read_b64_tr_b16 v[114:115], v10 offset:1536
  s_waitcnt lgkmcnt(6)
  v_mfma_f32_32x32x16_bf16 v[32:47], v[100:103], v[180:183], v[32:47]
  ds_read_b64_tr_b16 v[96:97], v10 offset:2048
  ds_read_b64_tr_b16 v[98:99], v10 offset:3072
  s_add_u32 s97, s88, 65536
  buffer_load_dwordx4 v[216:219], v1, s[40:43], s97 offen offset:0 sc1
  s_add_u32 m0, s50, 98304
  s_xor_b32 s72, s92, 1703936
  buffer_load_dwordx4 v6, s[28:31], s72 offen lds
  s_waitcnt lgkmcnt(6)
  v_mfma_f32_32x32x16_bf16 v[48:63], v[104:107], v[180:183], v[48:63]
  ds_read_b64_tr_b16 v[100:101], v10 offset:2560
  ds_read_b64_tr_b16 v[102:103], v10 offset:3584
  v_xor_b32 v10, 32768, v11
  s_waitcnt vmcnt(16)
  s_barrier
  v_max3_u32 v26, v184, v185, v186
  v_max3_u32 v26, v26, v187, v188
  v_max3_u32 v26, v26, v189, v190
  v_max_u32 v26, v26, v191
  v_cmp_eq_u32 vcc, -1, v26
  s_nop 3
  s_cbranch_vccnz OVOK_69
VOK_69:
  s_waitcnt lgkmcnt(6)
  v_mfma_f32_32x32x16_bf16 v[32:47], v[108:111], v[184:187], v[32:47]
  ds_read_b64_tr_b16 v[104:105], v10 offset:0
  ds_read_b64_tr_b16 v[106:107], v10 offset:1024
  s_add_u32 s97, s88, 65536
  buffer_load_dwordx4 v[220:223], v1, s[40:43], s97 offen offset:1024 sc1
  s_add_u32 m0, s50, 99328
  s_nop 0
  buffer_load_dwordx4 v7, s[28:31], s72 offen lds
  s_waitcnt lgkmcnt(6)
  v_mfma_f32_32x32x16_bf16 v[48:63], v[112:115], v[184:187], v[48:63]
  ds_read_b64_tr_b16 v[108:109], v10 offset:512
  ds_read_b64_tr_b16 v[110:111], v10 offset:1536
  s_waitcnt lgkmcnt(6)
  v_mfma_f32_32x32x16_bf16 v[32:47], v[96:99], v[188:191], v[32:47]
  ds_read_b64_tr_b16 v[112:113], v10 offset:2048
  ds_read_b64_tr_b16 v[114:115], v10 offset:3072
  s_add_u32 m0, s50, 114688
  s_xor_b32 s72, s91, 0
  buffer_load_dwordx4 v6, s[16:19], s72 offen lds
  s_waitcnt lgkmcnt(6)
  v_mfma_f32_32x32x16_bf16 v[48:63], v[100:103], v[188:191], v[48:63]
  ds_read_b64_tr_b16 v[96:97], v10 offset:2560
  ds_read_b64_tr_b16 v[98:99], v10 offset:3584
  v_xor_b32 v10, 147456, v11
  s_waitcnt vmcnt(17)
  s_barrier
  s_waitcnt vmcnt(13)
  v_max3_u32 v26, v192, v193, v194
  s_waitcnt vmcnt(12)
  v_max3_u32 v26, v26, v195, v196
  v_max3_u32 v26, v26, v197, v198
  v_max_u32 v26, v26, v199
  v_cmp_eq_u32 vcc, -1, v26
  s_nop 3
  s_cbranch_vccnz OVOK_71
VOK_71:
  s_waitcnt lgkmcnt(6)
  v_mfma_f32_32x32x16_bf16 v[32:47], v[104:107], v[192:195], v[32:47]
  ds_read_b64_tr_b16 v[100:101], v10 offset:0
  ds_read_b64_tr_b16 v[102:103], v10 offset:1024
  s_add_u32 s97, s89, 98304
  buffer_load_dwordx4 v[224:227], v1, s[40:43], s97 offen offset:0 sc1
  s_add_u32 m0, s50, 115712
  s_nop 0
  buffer_load_dwordx4 v7, s[16:19], s72 offen lds
  s_waitcnt lgkmcnt(6)
  v_mfma_f32_32x32x16_bf16 v[48:63], v[108:111], v[192:195], v[48:63]
  ds_read_b64_tr_b16 v[104:105], v10 offset:512
  ds_read_b64_tr_b16 v[106:107], v10 offset:1536
  s_waitcnt lgkmcnt(6)
  v_mfma_f32_32x32x16_bf16 v[32:47], v[112:115], v[196:199], v[32:47]
  ds_read_b64_tr_b16 v[108:109], v10 offset:2048
  ds_read_b64_tr_b16 v[110:111], v10 offset:3072
  s_add_u32 s97, s89, 98304
  buffer_load_dwordx4 v[228:231], v1, s[40:43], s97 offen offset:1024 sc1
  s_waitcnt lgkmcnt(6)
  v_mfma_f32_32x32x16_bf16 v[48:63], v[96:99], v[196:199], v[48:63]
  ds_read_b64_tr_b16 v[112:113], v10 offset:2560
  ds_read_b64_tr_b16 v[114:115], v10 offset:3584
  v_xor_b32 v10, 49152, v11
  s_barrier
  s_waitcnt vmcnt(14)
  v_max3_u32 v26, v200, v201, v202
  s_waitcnt vmcnt(13)
  v_max3_u32 v26, v26, v203, v204
  v_max3_u32 v26, v26, v205, v206
  v_max_u32 v26, v26, v207
  v_cmp_eq_u32 vcc, -1, v26
  s_nop 3
  s_cbranch_vccnz OVOK_73
VOK_73:
  s_waitcnt lgkmcnt(6)
  v_mfma_f32_32x32x16_bf16 v[32:47], v[100:103], v[200:203], v[32:47]
  ds_read_b64_tr_b16 v[96:97], v10 offset:0
  ds_read_b64_tr_b16 v[98:99], v10 offset:1024
  s_add_u32 s97, s90, 98304
  buffer_load_dwordx4 v[232:235], v1, s[40:43], s97 offen offset:0 sc1
  s_add_u32 m0, s50, 16384
  s_xor_b32 s72, s91, 131072
  buffer_load_dwordx4 v6, s[16:19], s72 offen lds
  s_waitcnt lgkmcnt(6)
  v_mfma_f32_32x32x16_bf16 v[48:63], v[104:107], v[200:203], v[48:63]
  ds_read_b64_tr_b16 v[100:101], v10 offset:512
  ds_read_b64_tr_b16 v[102:103], v10 offset:1536
  s_waitcnt lgkmcnt(6)
  v_mfma_f32_32x32x16_bf16 v[32:47], v[108:111], v[204:207], v[32:47]
  ds_read_b64_tr_b16 v[104:105], v10 offset:2048
  ds_read_b64_tr_b16 v[106:107], v10 offset:3072
  s_add_u32 s97, s90, 98304
  buffer_load_dwordx4 v[236:239], v1, s[40:43], s97 offen offset:1024 sc1
  v_lshrrev_b32 v19, 3, v0
  v_lshlrev_b32 v19, 10, v19
  v_and_b32 v20, 7, v0
  v_lshl_add_u32 v19, v20, 4, v19
  buffer_load_dwordx4 v[28:31], v19, s[4:7], s73 offen
  s_add_u32 m0, s50, 17408
  s_nop 0
  buffer_load_dwordx4 v7, s[16:19], s72 offen lds
  s_waitcnt lgkmcnt(6)
  v_mfma_f32_32x32x16_bf16 v[48:63], v[112:115], v[204:207], v[48:63]
  ds_read_b64_tr_b16 v[108:109], v10 offset:2560
  ds_read_b64_tr_b16 v[110:111], v10 offset:3584
  v_xor_b32 v10, 81920, v11
  s_waitcnt vmcnt(17)
  s_barrier
  s_waitcnt vmcnt(15)
  v_max3_u32 v26, v208, v209, v210
  s_waitcnt vmcnt(13)
  v_max3_u32 v26, v26, v211, v212
  v_max3_u32 v26, v26, v213, v214
  v_max_u32 v26, v26, v215
  v_cmp_eq_u32 vcc, -1, v26
  s_nop 3
  s_cbranch_vccnz OVOK_75
VOK_75:
  s_waitcnt lgkmcnt(6)
  v_mfma_f32_32x32x16_bf16 v[32:47], v[96:99], v[208:211], v[32:47]
  ds_read_b64_tr_b16 v[112:113], v10 offset:0
  ds_read_b64_tr_b16 v[114:115], v10 offset:1024
  s_add_u32 m0, s50, 131072
  s_xor_b32 s72, s91, 262144
  buffer_load_dwordx4 v6, s[16:19], s72 offen lds
  s_waitcnt lgkmcnt(6)
  v_mfma_f32_32x32x16_bf16 v[48:63], v[100:103], v[208:211], v[48:63]
  ds_read_b64_tr_b16 v[96:97], v10 offset:512
  ds_read_b64_tr_b16 v[98:99], v10 offset:1536
  s_waitcnt lgkmcnt(6)
  v_mfma_f32_32x32x16_bf16 v[32:47], v[104:107], v[212:215], v[32:47]
  ds_read_b64_tr_b16 v[100:101], v10 offset:2048
  ds_read_b64_tr_b16 v[102:103], v10 offset:3072
  s_add_u32 s97, s85, 114688
  buffer_load_dwordx4 v[240:243], v1, s[40:43], s97 offen offset:0 sc1
  s_add_u32 m0, s50, 132096
  s_nop 0
  buffer_load_dwordx4 v7, s[16:19], s72 offen lds
  s_waitcnt lgkmcnt(6)
  v_mfma_f32_32x32x16_bf16 v[48:63], v[108:111], v[212:215], v[48:63]
  ds_read_b64_tr_b16 v[104:105], v10 offset:2560
  ds_read_b64_tr_b16 v[106:107], v10 offset:3584
  v_xor_b32 v10, 65536, v11
  s_barrier
  s_waitcnt vmcnt(15)
  v_max3_u32 v26, v216, v217, v218
  s_waitcnt vmcnt(13)
  v_max3_u32 v26, v26, v219, v220
  v_max3_u32 v26, v26, v221, v222
  v_max_u32 v26, v26, v223
  v_cmp_eq_u32 vcc, -1, v26
  s_nop 3
  s_cbranch_vccnz OVOK_77
VOK_77:
  s_waitcnt lgkmcnt(6)
  v_mfma_f32_32x32x16_bf16 v[32:47], v[112:115], v[216:219], v[32:47]
  ds_read_b64_tr_b16 v[108:109], v10 offset:0
  ds_read_b64_tr_b16 v[110:111], v10 offset:1024
  s_add_u32 s97, s85, 114688
  buffer_load_dwordx4 v[244:247], v1, s[40:43], s97 offen offset:1024 sc1
  s_waitcnt lgkmcnt(6)
  v_mfma_f32_32x32x16_bf16 v[48:63], v[96:99], v[216:219], v[48:63]
  ds_read_b64_tr_b16 v[112:113], v10 offset:512
  ds_read_b64_tr_b16 v[114:115], v10 offset:1536
  s_waitcnt lgkmcnt(6)
  v_mfma_f32_32x32x16_bf16 v[32:47], v[100:103], v[220:223], v[32:47]
  ds_read_b64_tr_b16 v[96:97], v10 offset:2048
  ds_read_b64_tr_b16 v[98:99], v10 offset:3072
  s_add_u32 s97, s86, 114688
  buffer_load_dwordx4 v[248:251], v1, s[40:43], s97 offen offset:0 sc1
  s_add_u32 m0, s50, 32768
  s_xor_b32 s72, s91, 393216
  buffer_load_dwordx4 v6, s[16:19], s72 offen lds
  s_waitcnt lgkmcnt(6)
  v_mfma_f32_32x32x16_bf16 v[48:63], v[104:107], v[220:223], v[48:63]
  ds_read_b64_tr_b16 v[100:101], v10 offset:2560
  ds_read_b64_tr_b16 v[102:103], v10 offset:3584
  v_xor_b32 v10, 98304, v11
  s_waitcnt vmcnt(15)
  s_barrier
  s_waitcnt vmcnt(13)
  v_max3_u32 v26, v224, v225, v226
  s_waitcnt vmcnt(11)
  v_max3_u32 v26, v26, v227, v228
  v_max3_u32 v26, v26, v229, v230
  v_max_u32 v26, v26, v231
  v_cmp_eq_u32 vcc, -1, v26
  s_nop 3
  s_cbranch_vccnz OVOK_79
VOK_79:
  s_waitcnt lgkmcnt(6)
  v_mfma_f32_32x32x16_bf16 v[32:47], v[108:111], v[224:227], v[32:47]
  ds_read_b64_tr_b16 v[104:105], v10 offset:0
  ds_read_b64_tr_b16 v[106:107], v10 offset:1024
  s_add_u32 s97, s86, 114688
  buffer_load_dwordx4 v[252:255], v1, s[40:43], s97 offen offset:1024 sc1
  s_add_u32 m0, s50, 33792
  s_nop 0
  buffer_load_dwordx4 v7, s[16:19], s72 offen lds
  s_waitcnt lgkmcnt(6)
  v_mfma_f32_32x32x16_bf16 v[48:63], v[112:115], v[224:227], v[48:63]
  ds_read_b64_tr_b16 v[108:109], v10 offset:512
  ds_read_b64_tr_b16 v[110:111], v10 offset:1536
  s_waitcnt lgkmcnt(6)
  v_mfma_f32_32x32x16_bf16 v[32:47], v[96:99], v[228:231], v[32:47]
  ds_read_b64_tr_b16 v[112:113], v10 offset:2048
  ds_read_b64_tr_b16 v[114:115], v10 offset:3072
  s_add_u32 s97, s87, 114688
  buffer_load_dwordx4 v[128:131], v1, s[40:43], s97 offen offset:0 sc1
  s_waitcnt lgkmcnt(6)
  v_mfma_f32_32x32x16_bf16 v[48:63], v[100:103], v[228:231], v[48:63]
  ds_read_b64_tr_b16 v[96:97], v10 offset:2560
  ds_read_b64_tr_b16 v[98:99], v10 offset:3584
  v_xor_b32 v10, 114688, v11
  s_barrier
  s_waitcnt vmcnt(13)
  v_max3_u32 v26, v232, v233, v234
  s_waitcnt vmcnt(11)
  v_max3_u32 v26, v26, v235, v236
  v_max3_u32 v26, v26, v237, v238
  v_max_u32 v26, v26, v239
  v_cmp_eq_u32 vcc, -1, v26
  s_nop 3
  s_cbranch_vccnz OVOK_81
VOK_81:
  s_waitcnt lgkmcnt(6)
  v_mfma_f32_32x32x16_bf16 v[32:47], v[104:107], v[232:235], v[32:47]
  ds_read_b64_tr_b16 v[100:101], v10 offset:0
  ds_read_b64_tr_b16 v[102:103], v10 offset:1024
  s_add_u32 s97, s87, 114688
  buffer_load_dwordx4 v[132:135], v1, s[40:43], s97 offen offset:1024 sc1
  s_add_u32 s97, s88, 114688
  buffer_load_dwordx4 v[136:139], v1, s[40:43], s97 offen offset:0 sc1
  s_waitcnt lgkmcnt(6)
  v_mfma_f32_32x32x16_bf16 v[48:63], v[108:111], v[232:235], v[48:63]
  ds_read_b64_tr_b16 v[104:105], v10 offset:512
  ds_read_b64_tr_b16 v[106:107], v10 offset:1536
  s_waitcnt lgkmcnt(6)
  v_mfma_f32_32x32x16_bf16 v[32:47], v[112:115], v[236:239], v[32:47]
  ds_read_b64_tr_b16 v[108:109], v10 offset:2048
  ds_read_b64_tr_b16 v[110:111], v10 offset:3072
  s_add_u32 s97, s88, 114688
  buffer_load_dwordx4 v[140:143], v1, s[40:43], s97 offen offset:1024 sc1
  s_waitcnt lgkmcnt(6)
  v_mfma_f32_32x32x16_bf16 v[48:63], v[96:99], v[236:239], v[48:63]
  ds_read_b64_tr_b16 v[112:113], v10 offset:2560
  ds_read_b64_tr_b16 v[114:115], v10 offset:3584
  v_xor_b32 v10, 16384, v11
  s_waitcnt vmcnt(12)
  s_barrier
  s_waitcnt vmcnt(10)
  v_max3_u32 v26, v240, v241, v242
  s_waitcnt vmcnt(8)
  v_max3_u32 v26, v26, v243, v244
  v_max3_u32 v26, v26, v245, v246
  v_max_u32 v26, v26, v247
  v_cmp_eq_u32 vcc, -1, v26
  s_nop 3
  s_cbranch_vccnz OVOK_83
VOK_83:
  s_waitcnt lgkmcnt(6)
  v_mfma_f32_32x32x16_bf16 v[32:47], v[100:103], v[240:243], v[32:47]
  ds_read_b64_tr_b16 v[96:97], v10 offset:0
  ds_read_b64_tr_b16 v[98:99], v10 offset:1024
  s_waitcnt lgkmcnt(6)
  v_mfma_f32_32x32x16_bf16 v[48:63], v[104:107], v[240:243], v[48:63]
  ds_read_b64_tr_b16 v[100:101], v10 offset:512
  ds_read_b64_tr_b16 v[102:103], v10 offset:1536
  s_waitcnt lgkmcnt(6)
  v_mfma_f32_32x32x16_bf16 v[32:47], v[108:111], v[244:247], v[32:47]
  ds_read_b64_tr_b16 v[104:105], v10 offset:2048
  ds_read_b64_tr_b16 v[106:107], v10 offset:3072
  s_waitcnt lgkmcnt(6)
  v_mfma_f32_32x32x16_bf16 v[48:63], v[112:115], v[244:247], v[48:63]
  ds_read_b64_tr_b16 v[108:109], v10 offset:2560
  ds_read_b64_tr_b16 v[110:111], v10 offset:3584
  v_xor_b32 v10, 131072, v11
  s_barrier
  s_waitcnt vmcnt(7)
  v_max3_u32 v26, v248, v249, v250
  s_waitcnt vmcnt(5)
  v_max3_u32 v26, v26, v251, v252
  v_max3_u32 v26, v26, v253, v254
  v_max_u32 v26, v26, v255
  v_cmp_eq_u32 vcc, -1, v26
  s_nop 3
  s_cbranch_vccnz OVOK_85
VOK_85:
  s_waitcnt lgkmcnt(6)
  v_mfma_f32_32x32x16_bf16 v[32:47], v[96:99], v[248:251], v[32:47]
  ds_read_b64_tr_b16 v[112:113], v10 offset:0
  ds_read_b64_tr_b16 v[114:115], v10 offset:1024
  v_and_b32 v64, 31, v0
  v_lshrrev_b32 v65, 5, v0
  v_and_b32 v66, 7, v0
  v_xor_b32 v66, v66, v65
  v_lshlrev_b32 v66, 4, v66
  s_waitcnt lgkmcnt(6)
  v_mfma_f32_32x32x16_bf16 v[48:63], v[100:103], v[248:251], v[48:63]
  ds_read_b64_tr_b16 v[96:97], v10 offset:512
  ds_read_b64_tr_b16 v[98:99], v10 offset:1536
  v_lshl_add_u32 v64, v64, 8, v66
  s_lshr_b32 s56, s44, 1
  s_mov_b32 s57, 0
  s_cmp_eq_u32 s56, 1
  s_cselect_b32 s57, 49152, s57
  s_cmp_eq_u32 s56, 2
  s_cselect_b32 s57, 65536, s57
  s_cmp_eq_u32 s56, 3
  s_cselect_b32 s57, 81920, s57
  s_waitcnt lgkmcnt(6)
  v_mfma_f32_32x32x16_bf16 v[32:47], v[104:107], v[252:255], v[32:47]
  ds_read_b64_tr_b16 v[100:101], v10 offset:2048
  ds_read_b64_tr_b16 v[102:103], v10 offset:3072
  s_and_b32 s56, s44, 1
  s_lshl_b32 s56, s56, 13
  s_add_u32 s57, s57, s56
  v_add_u32 v64, s57, v64
  v_xor_b32 v65, 32, v64
  v_xor_b32 v66, 64, v64
  s_waitcnt lgkmcnt(6)
  v_mfma_f32_32x32x16_bf16 v[48:63], v[108:111], v[252:255], v[48:63]
  ds_read_b64_tr_b16 v[104:105], v10 offset:2560
  ds_read_b64_tr_b16 v[106:107], v10 offset:3584
  v_xor_b32 v67, 96, v64
  v_lshrrev_b32 v68, 3, v0
  v_and_b32 v69, 7, v0
  v_lshlrev_b32 v69, 1, v69
  v_xor_b32 v69, v69, v68
  v_xor_b32 v10, 32768, v11
  s_waitcnt vmcnt(4)
  s_barrier
  s_waitcnt vmcnt(3)
  v_max3_u32 v26, v128, v129, v130
  s_waitcnt vmcnt(2)
  v_max3_u32 v26, v26, v131, v132
  v_max3_u32 v26, v26, v133, v134
  v_max_u32 v26, v26, v135
  v_cmp_eq_u32 vcc, -1, v26
  s_nop 3
  s_cbranch_vccnz OVOK_87
VOK_87:
  s_waitcnt lgkmcnt(6)
  v_mfma_f32_32x32x16_bf16 v[32:47], v[112:115], v[128:131], v[32:47]
  ds_read_b64_tr_b16 v[108:109], v10 offset:0
  ds_read_b64_tr_b16 v[110:111], v10 offset:1024
  v_lshlrev_b32 v69, 4, v69
  v_lshl_add_u32 v68, v68, 8, v69
  v_add_u32 v68, s50, v68
  v_add_u32 v80, 0, v68
  v_xor_b32 v81, 16, v80
  s_waitcnt lgkmcnt(6)
  v_mfma_f32_32x32x16_bf16 v[48:63], v[96:99], v[128:131], v[48:63]
  ds_read_b64_tr_b16 v[112:113], v10 offset:512
  ds_read_b64_tr_b16 v[114:115], v10 offset:1536
  v_add_u32 v82, 49152, v68
  v_xor_b32 v83, 16, v82
  v_add_u32 v84, 65536, v68
  v_xor_b32 v85, 16, v84
  v_add_u32 v86, 81920, v68
  s_waitcnt lgkmcnt(6)
  v_mfma_f32_32x32x16_bf16 v[32:47], v[100:103], v[132:135], v[32:47]
  ds_read_b64_tr_b16 v[96:97], v10 offset:2048
  ds_read_b64_tr_b16 v[98:99], v10 offset:3072
  v_xor_b32 v87, 16, v86
  v_lshlrev_b32 v72, 16, v28
  v_and_b32 v73, 0xffff0000, v28
  v_lshlrev_b32 v74, 16, v29
  v_and_b32 v75, 0xffff0000, v29
  s_waitcnt lgkmcnt(6)
  v_mfma_f32_32x32x16_bf16 v[48:63], v[104:107], v[132:135], v[48:63]
  ds_read_b64_tr_b16 v[100:101], v10 offset:2560
  ds_read_b64_tr_b16 v[102:103], v10 offset:3584
  v_lshlrev_b32 v76, 16, v30
  v_and_b32 v77, 0xffff0000, v30
  v_lshlrev_b32 v78, 16, v31
  v_and_b32 v79, 0xffff0000, v31
  s_waitcnt vmcnt(1)
  v_max3_u32 v26, v136, v137, v138
  s_waitcnt vmcnt(0)
  v_max3_u32 v26, v26, v139, v140
  v_max3_u32 v26, v26, v141, v142
  v_max_u32 v26, v26, v143
  v_cmp_eq_u32 vcc, -1, v26
  s_nop 3
  s_cbranch_vccnz OVOK_89
VOK_89:
  s_waitcnt lgkmcnt(6)
  v_mfma_f32_32x32x16_bf16 v[32:47], v[108:111], v[136:139], v[32:47]
  s_waitcnt lgkmcnt(4)
  v_mfma_f32_32x32x16_bf16 v[48:63], v[112:115], v[136:139], v[48:63]
  s_waitcnt lgkmcnt(2)
  v_mfma_f32_32x32x16_bf16 v[32:47], v[96:99], v[140:143], v[32:47]
  s_waitcnt lgkmcnt(0)
  v_mfma_f32_32x32x16_bf16 v[48:63], v[100:103], v[140:143], v[48:63]
  s_nop 9
  ds_write_b128 v64, v[32:35] offset:0
  ds_write_b128 v65, v[36:39] offset:0
  ds_write_b128 v66, v[40:43] offset:0
  ds_write_b128 v67, v[44:47] offset:0
  ds_write_b128 v64, v[48:51] offset:128
  ds_write_b128 v65, v[52:55] offset:128
  ds_write_b128 v66, v[56:59] offset:128
  ds_write_b128 v67, v[60:63] offset:128
  s_waitcnt lgkmcnt(0)
  s_barrier
  ds_read_b128 v[160:163], v80
  ds_read_b128 v[164:167], v81
  ds_read_b128 v[168:171], v82
  ds_read_b128 v[172:175], v83
  ds_read_b128 v[176:179], v84
  ds_read_b128 v[180:183], v85
  ds_read_b128 v[184:187], v86
  ds_read_b128 v[188:191], v87
  s_waitcnt lgkmcnt(7)
  v_add_f32 v72, v72, v160
  v_add_f32 v73, v73, v161
  v_add_f32 v74, v74, v162
  v_add_f32 v75, v75, v163
  s_waitcnt lgkmcnt(6)
  v_add_f32 v76, v76, v164
  v_add_f32 v77, v77, v165
  v_add_f32 v78, v78, v166
  v_add_f32 v79, v79, v167
  s_waitcnt lgkmcnt(5)
  v_add_f32 v72, v72, v168
  v_add_f32 v73, v73, v169
  v_add_f32 v74, v74, v170
  v_add_f32 v75, v75, v171
  s_waitcnt lgkmcnt(4)
  v_add_f32 v76, v76, v172
  v_add_f32 v77, v77, v173
  v_add_f32 v78, v78, v174
  v_add_f32 v79, v79, v175
  s_waitcnt lgkmcnt(3)
  v_add_f32 v72, v72, v176
  v_add_f32 v73, v73, v177
  v_add_f32 v74, v74, v178
  v_add_f32 v75, v75, v179
  s_waitcnt lgkmcnt(2)
  v_add_f32 v76, v76, v180
  v_add_f32 v77, v77, v181
  v_add_f32 v78, v78, v182
  v_add_f32 v79, v79, v183
  s_waitcnt lgkmcnt(1)
  v_add_f32 v72, v72, v184
  v_add_f32 v73, v73, v185
  v_add_f32 v74, v74, v186
  v_add_f32 v75, v75, v187
  s_waitcnt lgkmcnt(0)
  v_add_f32 v76, v76, v188
  v_add_f32 v77, v77, v189
  v_add_f32 v78, v78, v190
  v_add_f32 v79, v79, v191
  v_cvt_pk_bf16_f32 v120, v72, v73
  v_cvt_pk_bf16_f32 v121, v74, v75
  v_cvt_pk_bf16_f32 v122, v76, v77
  v_cvt_pk_bf16_f32 v123, v78, v79
  buffer_store_dwordx4 v[120:123], v19, s[32:35], s73 offen
  s_endpgm
OTSK_1:
  s_memrealtime s[68:69]
  v_mov_b32 v26, 0
  v_mov_b32 v27, 0
  s_waitcnt lgkmcnt(0)
  s_or_b32 s69, s69, 0x40000000
  v_mov_b32 v24, s68
  v_mov_b32 v25, s69
  s_mov_b64 exec, 1
  buffer_atomic_cmpswap_x2 v[24:27], off, s[36:39], 0 sc1
  s_mov_b64 exec, -1
  s_nop 1
  s_branch TSK_1
OSOK_2:
  s_nop 0
  v_readfirstlane_b32 s51, v89
  s_nop 1
  s_cmp_lg_u32 s51, 0
  s_cbranch_scc0 SOK_2
  v_mov_b32 v82, v88
  v_mov_b32 v83, v89
  s_mov_b64 exec, 0xff
  buffer_store_dwordx4 v[80:83], v1, s[40:43], s101 offen sc1
  s_mov_b64 exec, -1
  v_mov_b32 v88, 0
  ds_write_b64 v88, v[82:83] offset:4160
  s_mov_b32 s67, 1
  s_branch SOK_2
OSOK_5:
  s_nop 0
  v_readfirstlane_b32 s51, v91
  s_nop 1
  s_cmp_lg_u32 s51, 0
  s_cbranch_scc0 SOK_5
  v_mov_b32 v82, v90
  v_mov_b32 v83, v91
  s_mov_b64 exec, 0xff
  buffer_store_dwordx4 v[80:83], v1, s[40:43], s101 offen sc1
  s_mov_b64 exec, -1
  v_mov_b32 v90, 0
  ds_write_b64 v90, v[82:83] offset:4160
  s_mov_b32 s67, 1
  s_branch SOK_5
OSOK_8:
  s_waitcnt vmcnt(8)
  v_readfirstlane_b32 s51, v93
  s_nop 1
  s_cmp_lg_u32 s51, 0
  s_cbranch_scc1 SGO_10
  s_mov_b32 s66, 20000
SLP_9:
  buffer_load_dwordx2 v[92:93], off, s[36:39], 0 sc1
  s_waitcnt vmcnt(0)
  v_readfirstlane_b32 s51, v93
  s_nop 1
  s_cmp_lg_u32 s51, 0
  s_cbranch_scc1 SGO_10
  s_sleep 2
  s_sub_u32 s66, s66, 1
  s_cmp_lg_u32 s66, 0
  s_cbranch_scc1 SLP_9
SGO_10:
  v_mov_b32 v82, v92
  v_mov_b32 v83, v93
  s_mov_b64 exec, 0xff
  buffer_store_dwordx4 v[80:83], v1, s[40:43], s101 offen sc1
  s_mov_b64 exec, -1
  v_mov_b32 v92, 0
  ds_write_b64 v92, v[82:83] offset:4160
  s_mov_b32 s67, 1
  s_branch SOK_8
OGOK_11:
  s_mov_b32 s66, 20000
GLP_12:
  s_sleep 8
  buffer_load_dwordx4 v[64:67], v70, s[40:43], s74 offen sc1
  s_waitcnt vmcnt(0)
  v_cmp_eq_u64 s[68:69], v[66:67], v[68:69]
  v_cmp_ne_u32 s[70:71], 0, v69
  s_nop 1
  s_and_b64 s[68:69], s[68:69], s[70:71]
  s_cmp_eq_u64 s[68:69], -1
  s_cbranch_scc1 GOK_11
  s_sub_u32 s66, s66, 1
  s_cmp_lg_u32 s66, 0
  s_cbranch_scc1 GLP_12
  s_branch GOK_11
OPUB_15:
  v_mov_b32 v26, s54
  v_mov_b32 v27, s55
  s_mov_b64 exec, 1
  buffer_store_dwordx2 v[26:27], off, s[40:43], s63 offset:448 sc1
  s_mov_b64 exec, -1
  s_branch PUB_15
OPUB_16:
  v_mov_b32 v26, s54
  v_mov_b32 v27, s55
  s_mov_b64 exec, 1
  buffer_store_dwordx2 v[26:27], off, s[40:43], s59 sc1
  s_mov_b64 exec, -1
  s_branch PUB_16
OPOK_13:
  s_waitcnt vmcnt(10)
  v_cmp_eq_u32 s[68:69], s54, v24
  v_cmp_eq_u32 s[70:71], s55, v25
  s_nop 1
  s_and_b64 s[68:69], s[68:69], s[70:71]
  s_cmp_eq_u64 s[68:69], -1
  s_cbranch_scc1 POK_13
  s_mov_b32 s66, 20000
PLP_14:
  buffer_load_dwordx2 v[24:25], v23, s[40:43], 0 offen sc1
  s_waitcnt vmcnt(0)
  v_cmp_eq_u32 s[68:69], s54, v24
  v_cmp_eq_u32 s[70:71], s55, v25
  s_nop 1
  s_and_b64 s[68:69], s[68:69], s[70:71]
  s_cmp_eq_u64 s[68:69], -1
  s_cbranch_scc1 POK_13
  s_sleep 2
  s_sub_u32 s66, s66, 1
  s_cmp_lg_u32 s66, 0
  s_cbranch_scc1 PLP_14
  s_branch POK_13
OVOK_17:
VLP_18:
  s_cmp_eq_u32 s0, 0
  s_cbranch_scc1 VOK_17
  s_sub_u32 s0, s0, 1
  s_waitcnt vmcnt(0)
  s_sleep 2
  s_add_u32 s97, s77, 32768
  buffer_load_dwordx4 v[160:163], v1, s[40:43], s97 offen offset:0 sc1
  s_add_u32 s97, s77, 32768
  buffer_load_dwordx4 v[164:167], v1, s[40:43], s97 offen offset:1024 sc1
  s_add_u32 s97, s78, 32768
  buffer_load_dwordx4 v[168:171], v1, s[40:43], s97 offen offset:0 sc1
  s_add_u32 s97, s78, 32768
  buffer_load_dwordx4 v[172:175], v1, s[40:43], s97 offen offset:1024 sc1
  s_add_u32 s97, s79, 32768
  buffer_load_dwordx4 v[176:179], v1, s[40:43], s97 offen offset:0 sc1
  s_add_u32 s97, s79, 32768
  buffer_load_dwordx4 v[180:183], v1, s[40:43], s97 offen offset:1024 sc1
  s_add_u32 s97, s80, 32768
  buffer_load_dwordx4 v[184:187], v1, s[40:43], s97 offen offset:0 sc1
  s_add_u32 s97, s80, 32768
  buffer_load_dwordx4 v[188:191], v1, s[40:43], s97 offen offset:1024 sc1
  s_add_u32 s97, s77, 65536
  buffer_load_dwordx4 v[192:195], v1, s[40:43], s97 offen offset:0 sc1
  s_add_u32 s97, s77, 65536
  buffer_load_dwordx4 v[196:199], v1, s[40:43], s97 offen offset:1024 sc1
  s_waitcnt vmcnt(0)
  v_max3_u32 v26, v160, v161, v162
  v_max3_u32 v26, v26, v163, v164
  v_max3_u32 v26, v26, v165, v166
  v_max_u32 v26, v26, v167
  v_cmp_eq_u32 vcc, -1, v26
  s_nop 3
  s_cbranch_vccnz VLP_18
  s_branch VOK_17
OVOK_19:
VLP_20:
  s_cmp_eq_u32 s0, 0
  s_cbranch_scc1 VOK_19
  s_sub_u32 s0, s0, 1
  s_waitcnt vmcnt(0)
  s_sleep 2
  s_add_u32 s97, s78, 32768
  buffer_load_dwordx4 v[168:171], v1, s[40:43], s97 offen offset:0 sc1
  s_add_u32 s97, s78, 32768
  buffer_load_dwordx4 v[172:175], v1, s[40:43], s97 offen offset:1024 sc1
  s_add_u32 s97, s79, 32768
  buffer_load_dwordx4 v[176:179], v1, s[40:43], s97 offen offset:0 sc1
  s_add_u32 s97, s79, 32768
  buffer_load_dwordx4 v[180:183], v1, s[40:43], s97 offen offset:1024 sc1
  s_add_u32 s97, s80, 32768
  buffer_load_dwordx4 v[184:187], v1, s[40:43], s97 offen offset:0 sc1
  s_add_u32 s97, s80, 32768
  buffer_load_dwordx4 v[188:191], v1, s[40:43], s97 offen offset:1024 sc1
  s_add_u32 s97, s77, 65536
  buffer_load_dwordx4 v[192:195], v1, s[40:43], s97 offen offset:0 sc1
  s_add_u32 s97, s77, 65536
  buffer_load_dwordx4 v[196:199], v1, s[40:43], s97 offen offset:1024 sc1
  s_add_u32 s97, s78, 65536
  buffer_load_dwordx4 v[200:203], v1, s[40:43], s97 offen offset:0 sc1
  s_add_u32 s97, s78, 65536
  buffer_load_dwordx4 v[204:207], v1, s[40:43], s97 offen offset:1024 sc1
  s_add_u32 s97, s79, 65536
  buffer_load_dwordx4 v[208:211], v1, s[40:43], s97 offen offset:0 sc1
  s_waitcnt vmcnt(0)
  v_max3_u32 v26, v168, v169, v170
  v_max3_u32 v26, v26, v171, v172
  v_max3_u32 v26, v26, v173, v174
  v_max_u32 v26, v26, v175
  v_cmp_eq_u32 vcc, -1, v26
  s_nop 3
  s_cbranch_vccnz VLP_20
  s_branch VOK_19
OVOK_21:
VLP_22:
  s_cmp_eq_u32 s0, 0
  s_cbranch_scc1 VOK_21
  s_sub_u32 s0, s0, 1
  s_waitcnt vmcnt(0)
  s_sleep 2
  s_add_u32 s97, s79, 32768
  buffer_load_dwordx4 v[176:179], v1, s[40:43], s97 offen offset:0 sc1
  s_add_u32 s97, s79, 32768
  buffer_load_dwordx4 v[180:183], v1, s[40:43], s97 offen offset:1024 sc1
  s_add_u32 s97, s80, 32768
  buffer_load_dwordx4 v[184:187], v1, s[40:43], s97 offen offset:0 sc1
  s_add_u32 s97, s80, 32768
  buffer_load_dwordx4 v[188:191], v1, s[40:43], s97 offen offset:1024 sc1
  s_add_u32 s97, s77, 65536
  buffer_load_dwordx4 v[192:195], v1, s[40:43], s97 offen offset:0 sc1
  s_add_u32 s97, s77, 65536
  buffer_load_dwordx4 v[196:199], v1, s[40:43], s97 offen offset:1024 sc1
  s_add_u32 s97, s78, 65536
  buffer_load_dwordx4 v[200:203], v1, s[40:43], s97 offen offset:0 sc1
  s_add_u32 s97, s78, 65536
  buffer_load_dwordx4 v[204:207], v1, s[40:43], s97 offen offset:1024 sc1
  s_add_u32 s97, s79, 65536
  buffer_load_dwordx4 v[208:211], v1, s[40:43], s97 offen offset:0 sc1
  s_add_u32 s97, s79, 65536
  buffer_load_dwordx4 v[212:215], v1, s[40:43], s97 offen offset:1024 sc1
  s_waitcnt vmcnt(0)
  v_max3_u32 v26, v176, v177, v178
  v_max3_u32 v26, v26, v179, v180
  v_max3_u32 v26, v26, v181, v182
  v_max_u32 v26, v26, v183
  v_cmp_eq_u32 vcc, -1, v26
  s_nop 3
  s_cbranch_vccnz VLP_22
  s_branch VOK_21
OVOK_23:
VLP_24:
  s_cmp_eq_u32 s0, 0
  s_cbranch_scc1 VOK_23
  s_sub_u32 s0, s0, 1
  s_waitcnt vmcnt(0)
  s_sleep 2
  s_add_u32 s97, s80, 32768
  buffer_load_dwordx4 v[184:187], v1, s[40:43], s97 offen offset:0 sc1
  s_add_u32 s97, s80, 32768
  buffer_load_dwordx4 v[188:191], v1, s[40:43], s97 offen offset:1024 sc1
  s_add_u32 s97, s77, 65536
  buffer_load_dwordx4 v[192:195], v1, s[40:43], s97 offen offset:0 sc1
  s_add_u32 s97, s77, 65536
  buffer_load_dwordx4 v[196:199], v1, s[40:43], s97 offen offset:1024 sc1
  s_add_u32 s97, s78, 65536
  buffer_load_dwordx4 v[200:203], v1, s[40:43], s97 offen offset:0 sc1
  s_add_u32 s97, s78, 65536
  buffer_load_dwordx4 v[204:207], v1, s[40:43], s97 offen offset:1024 sc1
  s_add_u32 s97, s79, 65536
  buffer_load_dwordx4 v[208:211], v1, s[40:43], s97 offen offset:0 sc1
  s_add_u32 s97, s79, 65536
  buffer_load_dwordx4 v[212:215], v1, s[40:43], s97 offen offset:1024 sc1
  s_add_u32 s97, s80, 65536
  buffer_load_dwordx4 v[216:219], v1, s[40:43], s97 offen offset:0 sc1
  s_waitcnt vmcnt(0)
  v_max3_u32 v26, v184, v185, v186
  v_max3_u32 v26, v26, v187, v188
  v_max3_u32 v26, v26, v189, v190
  v_max_u32 v26, v26, v191
  v_cmp_eq_u32 vcc, -1, v26
  s_nop 3
  s_cbranch_vccnz VLP_24
  s_branch VOK_23
OVOK_25:
VLP_26:
  s_cmp_eq_u32 s0, 0
  s_cbranch_scc1 VOK_25
  s_sub_u32 s0, s0, 1
  s_waitcnt vmcnt(0)
  s_sleep 2
  s_add_u32 s97, s77, 65536
  buffer_load_dwordx4 v[192:195], v1, s[40:43], s97 offen offset:0 sc1
  s_add_u32 s97, s77, 65536
  buffer_load_dwordx4 v[196:199], v1, s[40:43], s97 offen offset:1024 sc1
  s_add_u32 s97, s78, 65536
  buffer_load_dwordx4 v[200:203], v1, s[40:43], s97 offen offset:0 sc1
  s_add_u32 s97, s78, 65536
  buffer_load_dwordx4 v[204:207], v1, s[40:43], s97 offen offset:1024 sc1
  s_add_u32 s97, s79, 65536
  buffer_load_dwordx4 v[208:211], v1, s[40:43], s97 offen offset:0 sc1
  s_add_u32 s97, s79, 65536
  buffer_load_dwordx4 v[212:215], v1, s[40:43], s97 offen offset:1024 sc1
  s_add_u32 s97, s80, 65536
  buffer_load_dwordx4 v[216:219], v1, s[40:43], s97 offen offset:0 sc1
  s_add_u32 s97, s80, 65536
  buffer_load_dwordx4 v[220:223], v1, s[40:43], s97 offen offset:1024 sc1
  s_add_u32 s97, s81, 98304
  buffer_load_dwordx4 v[224:227], v1, s[40:43], s97 offen offset:0 sc1
  s_waitcnt vmcnt(0)
  v_max3_u32 v26, v192, v193, v194
  v_max3_u32 v26, v26, v195, v196
  v_max3_u32 v26, v26, v197, v198
  v_max_u32 v26, v26, v199
  v_cmp_eq_u32 vcc, -1, v26
  s_nop 3
  s_cbranch_vccnz VLP_26
  s_branch VOK_25
OVOK_27:
VLP_28:
  s_cmp_eq_u32 s0, 0
  s_cbranch_scc1 VOK_27
  s_sub_u32 s0, s0, 1
  s_waitcnt vmcnt(0)
  s_sleep 2
  s_add_u32 s97, s78, 65536
  buffer_load_dwordx4 v[200:203], v1, s[40:43], s97 offen offset:0 sc1
  s_add_u32 s97, s78, 65536
  buffer_load_dwordx4 v[204:207], v1, s[40:43], s97 offen offset:1024 sc1
  s_add_u32 s97, s79, 65536
  buffer_load_dwordx4 v[208:211], v1, s[40:43], s97 offen offset:0 sc1
  s_add_u32 s97, s79, 65536
  buffer_load_dwordx4 v[212:215], v1, s[40:43], s97 offen offset:1024 sc1
  s_add_u32 s97, s80, 65536
  buffer_load_dwordx4 v[216:219], v1, s[40:43], s97 offen offset:0 sc1
  s_add_u32 s97, s80, 65536
  buffer_load_dwordx4 v[220:223], v1, s[40:43], s97 offen offset:1024 sc1
  s_add_u32 s97, s81, 98304
  buffer_load_dwordx4 v[224:227], v1, s[40:43], s97 offen offset:0 sc1
  s_add_u32 s97, s81, 98304
  buffer_load_dwordx4 v[228:231], v1, s[40:43], s97 offen offset:1024 sc1
  s_add_u32 s97, s82, 98304
  buffer_load_dwordx4 v[232:235], v1, s[40:43], s97 offen offset:0 sc1
  s_waitcnt vmcnt(0)
  v_max3_u32 v26, v200, v201, v202
  v_max3_u32 v26, v26, v203, v204
  v_max3_u32 v26, v26, v205, v206
  v_max_u32 v26, v26, v207
  v_cmp_eq_u32 vcc, -1, v26
  s_nop 3
  s_cbranch_vccnz VLP_28
  s_branch VOK_27
OVOK_29:
VLP_30:
  s_cmp_eq_u32 s0, 0
  s_cbranch_scc1 VOK_29
  s_sub_u32 s0, s0, 1
  s_waitcnt vmcnt(0)
  s_sleep 2
  s_add_u32 s97, s79, 65536
  buffer_load_dwordx4 v[208:211], v1, s[40:43], s97 offen offset:0 sc1
  s_add_u32 s97, s79, 65536
  buffer_load_dwordx4 v[212:215], v1, s[40:43], s97 offen offset:1024 sc1
  s_add_u32 s97, s80, 65536
  buffer_load_dwordx4 v[216:219], v1, s[40:43], s97 offen offset:0 sc1
  s_add_u32 s97, s80, 65536
  buffer_load_dwordx4 v[220:223], v1, s[40:43], s97 offen offset:1024 sc1
  s_add_u32 s97, s81, 98304
  buffer_load_dwordx4 v[224:227], v1, s[40:43], s97 offen offset:0 sc1
  s_add_u32 s97, s81, 98304
  buffer_load_dwordx4 v[228:231], v1, s[40:43], s97 offen offset:1024 sc1
  s_add_u32 s97, s82, 98304
  buffer_load_dwordx4 v[232:235], v1, s[40:43], s97 offen offset:0 sc1
  s_add_u32 s97, s82, 98304
  buffer_load_dwordx4 v[236:239], v1, s[40:43], s97 offen offset:1024 sc1
  s_add_u32 s97, s77, 114688
  buffer_load_dwordx4 v[240:243], v1, s[40:43], s97 offen offset:0 sc1
  s_waitcnt vmcnt(0)
  v_max3_u32 v26, v208, v209, v210
  v_max3_u32 v26, v26, v211, v212
  v_max3_u32 v26, v26, v213, v214
  v_max_u32 v26, v26, v215
  v_cmp_eq_u32 vcc, -1, v26
  s_nop 3
  s_cbranch_vccnz VLP_30
  s_branch VOK_29
OVOK_31:
VLP_32:
  s_cmp_eq_u32 s0, 0
  s_cbranch_scc1 VOK_31
  s_sub_u32 s0, s0, 1
  s_waitcnt vmcnt(0)
  s_sleep 2
  s_add_u32 s97, s80, 65536
  buffer_load_dwordx4 v[216:219], v1, s[40:43], s97 offen offset:0 sc1
  s_add_u32 s97, s80, 65536
  buffer_load_dwordx4 v[220:223], v1, s[40:43], s97 offen offset:1024 sc1
  s_add_u32 s97, s81, 98304
  buffer_load_dwordx4 v[224:227], v1, s[40:43], s97 offen offset:0 sc1
  s_add_u32 s97, s81, 98304
  buffer_load_dwordx4 v[228:231], v1, s[40:43], s97 offen offset:1024 sc1
  s_add_u32 s97, s82, 98304
  buffer_load_dwordx4 v[232:235], v1, s[40:43], s97 offen offset:0 sc1
  s_add_u32 s97, s82, 98304
  buffer_load_dwordx4 v[236:239], v1, s[40:43], s97 offen offset:1024 sc1
  s_add_u32 s97, s77, 114688
  buffer_load_dwordx4 v[240:243], v1, s[40:43], s97 offen offset:0 sc1
  s_add_u32 s97, s77, 114688
  buffer_load_dwordx4 v[244:247], v1, s[40:43], s97 offen offset:1024 sc1
  s_waitcnt vmcnt(0)
  v_max3_u32 v26, v216, v217, v218
  v_max3_u32 v26, v26, v219, v220
  v_max3_u32 v26, v26, v221, v222
  v_max_u32 v26, v26, v223
  v_cmp_eq_u32 vcc, -1, v26
  s_nop 3
  s_cbranch_vccnz VLP_32
  s_branch VOK_31
OVOK_33:
VLP_34:
  s_cmp_eq_u32 s0, 0
  s_cbranch_scc1 VOK_33
  s_sub_u32 s0, s0, 1
  s_waitcnt vmcnt(0)
  s_sleep 2
  s_add_u32 s97, s81, 98304
  buffer_load_dwordx4 v[224:227], v1, s[40:43], s97 offen offset:0 sc1
  s_add_u32 s97, s81, 98304
  buffer_load_dwordx4 v[228:231], v1, s[40:43], s97 offen offset:1024 sc1
  s_add_u32 s97, s82, 98304
  buffer_load_dwordx4 v[232:235], v1, s[40:43], s97 offen offset:0 sc1
  s_add_u32 s97, s82, 98304
  buffer_load_dwordx4 v[236:239], v1, s[40:43], s97 offen offset:1024 sc1
  s_add_u32 s97, s77, 114688
  buffer_load_dwordx4 v[240:243], v1, s[40:43], s97 offen offset:0 sc1
  s_add_u32 s97, s77, 114688
  buffer_load_dwordx4 v[244:247], v1, s[40:43], s97 offen offset:1024 sc1
  s_add_u32 s97, s78, 114688
  buffer_load_dwordx4 v[248:251], v1, s[40:43], s97 offen offset:0 sc1
  s_waitcnt vmcnt(0)
  v_max3_u32 v26, v224, v225, v226
  v_max3_u32 v26, v26, v227, v228
  v_max3_u32 v26, v26, v229, v230
  v_max_u32 v26, v26, v231
  v_cmp_eq_u32 vcc, -1, v26
  s_nop 3
  s_cbranch_vccnz VLP_34
  s_branch VOK_33
OVOK_35:
VLP_36:
  s_cmp_eq_u32 s0, 0
  s_cbranch_scc1 VOK_35
  s_sub_u32 s0, s0, 1
  s_waitcnt vmcnt(0)
  s_sleep 2
  s_add_u32 s97, s82, 98304
  buffer_load_dwordx4 v[232:235], v1, s[40:43], s97 offen offset:0 sc1
  s_add_u32 s97, s82, 98304
  buffer_load_dwordx4 v[236:239], v1, s[40:43], s97 offen offset:1024 sc1
  s_add_u32 s97, s77, 114688
  buffer_load_dwordx4 v[240:243], v1, s[40:43], s97 offen offset:0 sc1
  s_add_u32 s97, s77, 114688
  buffer_load_dwordx4 v[244:247], v1, s[40:43], s97 offen offset:1024 sc1
  s_add_u32 s97, s78, 114688
  buffer_load_dwordx4 v[248:251], v1, s[40:43], s97 offen offset:0 sc1
  s_add_u32 s97, s78, 114688
  buffer_load_dwordx4 v[252:255], v1, s[40:43], s97 offen offset:1024 sc1
  s_add_u32 s97, s79, 114688
  buffer_load_dwordx4 v[128:131], v1, s[40:43], s97 offen offset:0 sc1
  s_add_u32 s97, s79, 114688
  buffer_load_dwordx4 v[132:135], v1, s[40:43], s97 offen offset:1024 sc1
  s_waitcnt vmcnt(0)
  v_max3_u32 v26, v232, v233, v234
  v_max3_u32 v26, v26, v235, v236
  v_max3_u32 v26, v26, v237, v238
  v_max_u32 v26, v26, v239
  v_cmp_eq_u32 vcc, -1, v26
  s_nop 3
  s_cbranch_vccnz VLP_36
  s_branch VOK_35
OVOK_37:
VLP_38:
  s_cmp_eq_u32 s0, 0
  s_cbranch_scc1 VOK_37
  s_sub_u32 s0, s0, 1
  s_waitcnt vmcnt(0)
  s_sleep 2
  s_add_u32 s97, s77, 114688
  buffer_load_dwordx4 v[240:243], v1, s[40:43], s97 offen offset:0 sc1
  s_add_u32 s97, s77, 114688
  buffer_load_dwordx4 v[244:247], v1, s[40:43], s97 offen offset:1024 sc1
  s_add_u32 s97, s78, 114688
  buffer_load_dwordx4 v[248:251], v1, s[40:43], s97 offen offset:0 sc1
  s_add_u32 s97, s78, 114688
  buffer_load_dwordx4 v[252:255], v1, s[40:43], s97 offen offset:1024 sc1
  s_add_u32 s97, s79, 114688
  buffer_load_dwordx4 v[128:131], v1, s[40:43], s97 offen offset:0 sc1
  s_add_u32 s97, s79, 114688
  buffer_load_dwordx4 v[132:135], v1, s[40:43], s97 offen offset:1024 sc1
  s_add_u32 s97, s80, 114688
  buffer_load_dwordx4 v[136:139], v1, s[40:43], s97 offen offset:0 sc1
  s_add_u32 s97, s80, 114688
  buffer_load_dwordx4 v[140:143], v1, s[40:43], s97 offen offset:1024 sc1
  s_waitcnt vmcnt(0)
  v_max3_u32 v26, v240, v241, v242
  v_max3_u32 v26, v26, v243, v244
  v_max3_u32 v26, v26, v245, v246
  v_max_u32 v26, v26, v247
  v_cmp_eq_u32 vcc, -1, v26
  s_nop 3
  s_cbranch_vccnz VLP_38
  s_branch VOK_37
OVOK_39:
VLP_40:
  s_cmp_eq_u32 s0, 0
  s_cbranch_scc1 VOK_39
  s_sub_u32 s0, s0, 1
  s_waitcnt vmcnt(0)
  s_sleep 2
  s_add_u32 s97, s78, 114688
  buffer_load_dwordx4 v[248:251], v1, s[40:43], s97 offen offset:0 sc1
  s_add_u32 s97, s78, 114688
  buffer_load_dwordx4 v[252:255], v1, s[40:43], s97 offen offset:1024 sc1
  s_add_u32 s97, s79, 114688
  buffer_load_dwordx4 v[128:131], v1, s[40:43], s97 offen offset:0 sc1
  s_add_u32 s97, s79, 114688
  buffer_load_dwordx4 v[132:135], v1, s[40:43], s97 offen offset:1024 sc1
  s_add_u32 s97, s80, 114688
  buffer_load_dwordx4 v[136:139], v1, s[40:43], s97 offen offset:0 sc1
  s_add_u32 s97, s80, 114688
  buffer_load_dwordx4 v[140:143], v1, s[40:43], s97 offen offset:1024 sc1
  s_waitcnt vmcnt(0)
  v_max3_u32 v26, v248, v249, v250
  v_max3_u32 v26, v26, v251, v252
  v_max3_u32 v26, v26, v253, v254
  v_max_u32 v26, v26, v255
  v_cmp_eq_u32 vcc, -1, v26
  s_nop 3
  s_cbranch_vccnz VLP_40
  s_branch VOK_39
OVOK_41:
VLP_42:
  s_cmp_eq_u32 s0, 0
  s_cbranch_scc1 VOK_41
  s_sub_u32 s0, s0, 1
  s_waitcnt vmcnt(0)
  s_sleep 2
  s_add_u32 s97, s79, 114688
  buffer_load_dwordx4 v[128:131], v1, s[40:43], s97 offen offset:0 sc1
  s_add_u32 s97, s79, 114688
  buffer_load_dwordx4 v[132:135], v1, s[40:43], s97 offen offset:1024 sc1
  s_add_u32 s97, s80, 114688
  buffer_load_dwordx4 v[136:139], v1, s[40:43], s97 offen offset:0 sc1
  s_add_u32 s97, s80, 114688
  buffer_load_dwordx4 v[140:143], v1, s[40:43], s97 offen offset:1024 sc1
  s_waitcnt vmcnt(0)
  v_max3_u32 v26, v128, v129, v130
  v_max3_u32 v26, v26, v131, v132
  v_max3_u32 v26, v26, v133, v134
  v_max_u32 v26, v26, v135
  v_cmp_eq_u32 vcc, -1, v26
  s_nop 3
  s_cbranch_vccnz VLP_42
  s_branch VOK_41
OVOK_43:
VLP_44:
  s_cmp_eq_u32 s0, 0
  s_cbranch_scc1 VOK_43
  s_sub_u32 s0, s0, 1
  s_waitcnt vmcnt(0)
  s_sleep 2
  s_add_u32 s97, s80, 114688
  buffer_load_dwordx4 v[136:139], v1, s[40:43], s97 offen offset:0 sc1
  s_add_u32 s97, s80, 114688
  buffer_load_dwordx4 v[140:143], v1, s[40:43], s97 offen offset:1024 sc1
  s_waitcnt vmcnt(0)
  v_max3_u32 v26, v136, v137, v138
  v_max3_u32 v26, v26, v139, v140
  v_max3_u32 v26, v26, v141, v142
  v_max_u32 v26, v26, v143
  v_cmp_eq_u32 vcc, -1, v26
  s_nop 3
  s_cbranch_vccnz VLP_44
  s_branch VOK_43
OSOK_45:
  s_nop 0
  v_readfirstlane_b32 s51, v73
  s_nop 1
  s_cmp_lg_u32 s51, 0
  s_cbranch_scc0 SOK_45
  v_mov_b32 v82, v72
  v_mov_b32 v83, v73
  s_mov_b64 exec, 0xff
  buffer_store_dwordx4 v[80:83], v1, s[40:43], s101 offen sc1
  s_mov_b64 exec, -1
  v_mov_b32 v72, 0
  ds_write_b64 v72, v[82:83] offset:4160
  s_mov_b32 s67, 1
  s_branch SOK_45
OSOK_48:
  s_nop 0
  v_readfirstlane_b32 s51, v75
  s_nop 1
  s_cmp_lg_u32 s51, 0
  s_cbranch_scc0 SOK_48
  v_mov_b32 v82, v74
  v_mov_b32 v83, v75
  s_mov_b64 exec, 0xff
  buffer_store_dwordx4 v[80:83], v1, s[40:43], s101 offen sc1
  s_mov_b64 exec, -1
  v_mov_b32 v74, 0
  ds_write_b64 v74, v[82:83] offset:4160
  s_mov_b32 s67, 1
  s_branch SOK_48
OSOK_51:
  s_waitcnt vmcnt(8)
  v_readfirstlane_b32 s51, v77
  s_nop 1
  s_cmp_lg_u32 s51, 0
  s_cbranch_scc1 SGO_53
  s_mov_b32 s66, 20000
SLP_52:
  buffer_load_dwordx2 v[76:77], off, s[36:39], 0 sc1
  s_waitcnt vmcnt(0)
  v_readfirstlane_b32 s51, v77
  s_nop 1
  s_cmp_lg_u32 s51, 0
  s_cbranch_scc1 SGO_53
  s_sleep 2
  s_sub_u32 s66, s66, 1
  s_cmp_lg_u32 s66, 0
  s_cbranch_scc1 SLP_52
SGO_53:
  v_mov_b32 v82, v76
  v_mov_b32 v83, v77
  s_mov_b64 exec, 0xff
  buffer_store_dwordx4 v[80:83], v1, s[40:43], s101 offen sc1
  s_mov_b64 exec, -1
  v_mov_b32 v76, 0
  ds_write_b64 v76, v[82:83] offset:4160
  s_mov_b32 s67, 1
  s_branch SOK_51
OGOK_54:
  s_mov_b32 s66, 20000
GLP_55:
  s_sleep 8
  buffer_load_dwordx4 v[64:67], v70, s[40:43], s74 offen sc1
  s_waitcnt vmcnt(0)
  v_cmp_eq_u64 s[68:69], v[66:67], v[68:69]
  v_cmp_ne_u32 s[70:71], 0, v69
  s_nop 1
  s_and_b64 s[68:69], s[68:69], s[70:71]
  s_cmp_eq_u64 s[68:69], -1
  s_cbranch_scc1 GOK_54
  s_sub_u32 s66, s66, 1
  s_cmp_lg_u32 s66, 0
  s_cbranch_scc1 GLP_55
  s_branch GOK_54
OPUB_62:
  v_mov_b32 v26, s54
  v_mov_b32 v27, s55
  s_mov_b64 exec, 1
  buffer_store_dwordx2 v[26:27], off, s[40:43], s63 offset:384 sc1
  s_mov_b64 exec, -1
  s_branch PUB_62
OPOK_56:
  s_waitcnt vmcnt(2)
  v_cmp_eq_u32 s[68:69], s54, v24
  v_cmp_eq_u32 s[70:71], s55, v25
  s_nop 1
  s_and_b64 s[68:69], s[68:69], s[70:71]
  s_cmp_eq_u64 s[68:69], -1
  s_cbranch_scc1 POK_56
  s_mov_b32 s66, 20000
PLP_57:
  buffer_load_dwordx2 v[24:25], v23, s[40:43], 0 offen sc1
  s_waitcnt vmcnt(0)
  v_cmp_eq_u32 s[68:69], s54, v24
  v_cmp_eq_u32 s[70:71], s55, v25
  s_nop 1
  s_and_b64 s[68:69], s[68:69], s[70:71]
  s_cmp_eq_u64 s[68:69], -1
  s_cbranch_scc1 POK_56
  s_sleep 2
  s_sub_u32 s66, s66, 1
  s_cmp_lg_u32 s66, 0
  s_cbranch_scc1 PLP_57
  s_branch POK_56
OPOK_58:
  s_waitcnt vmcnt(5)
  v_cmp_eq_u32 s[68:69], s54, v24
  v_cmp_eq_u32 s[70:71], s55, v25
  s_nop 1
  s_and_b64 s[68:69], s[68:69], s[70:71]
  s_cmp_eq_u64 s[68:69], -1
  s_cbranch_scc1 POK_58
  s_mov_b32 s66, 20000
PLP_59:
  buffer_load_dwordx2 v[24:25], v23, s[40:43], 0 offen sc1
  s_waitcnt vmcnt(0)
  v_cmp_eq_u32 s[68:69], s54, v24
  v_cmp_eq_u32 s[70:71], s55, v25
  s_nop 1
  s_and_b64 s[68:69], s[68:69], s[70:71]
  s_cmp_eq_u64 s[68:69], -1
  s_cbranch_scc1 POK_58
  s_sleep 2
  s_sub_u32 s66, s66, 1
  s_cmp_lg_u32 s66, 0
  s_cbranch_scc1 PLP_59
  s_branch POK_58
OVOK_60:
VLP_61:
  s_cmp_eq_u32 s0, 0
  s_cbranch_scc1 VOK_60
  s_sub_u32 s0, s0, 1
  s_waitcnt vmcnt(0)
  s_sleep 2
  s_add_u32 s57, s64, 4096
  buffer_load_dwordx4 v[208:211], v200, s[40:43], s64 offen offset:0 sc1
  buffer_load_dwordx4 v[212:215], v200, s[40:43], s64 offen offset:256 sc1
  buffer_load_dwordx4 v[216:219], v200, s[40:43], s64 offen offset:2048 sc1
  buffer_load_dwordx4 v[220:223], v200, s[40:43], s64 offen offset:2304 sc1
  buffer_load_dwordx4 v[224:227], v200, s[40:43], s57 offen offset:0 sc1
  buffer_load_dwordx4 v[228:231], v200, s[40:43], s57 offen offset:256 sc1
  buffer_load_dwordx4 v[232:235], v200, s[40:43], s57 offen offset:2048 sc1
  buffer_load_dwordx4 v[236:239], v200, s[40:43], s57 offen offset:2304 sc1
  buffer_load_dwordx4 v[240:243], v201, s[40:43], s65 offen offset:0 sc1
  buffer_load_dwordx4 v[244:247], v201, s[40:43], s65 offen offset:128 sc1
  buffer_load_dwordx4 v[248:251], v201, s[40:43], s65 offen offset:256 sc1
  buffer_load_dwordx4 v[252:255], v201, s[40:43], s65 offen offset:384 sc1
  s_waitcnt vmcnt(0)
  v_max3_u32 v204, v208, v209, v210
  v_max3_u32 v204, v204, v211, v212
  v_max3_u32 v204, v204, v213, v214
  v_max3_u32 v204, v204, v215, v216
  v_max3_u32 v204, v204, v217, v218
  v_max3_u32 v204, v204, v219, v220
  v_max3_u32 v204, v204, v221, v222
  v_max3_u32 v204, v204, v223, v224
  v_max3_u32 v204, v204, v225, v226
  v_max3_u32 v204, v204, v227, v228
  v_max3_u32 v204, v204, v229, v230
  v_max3_u32 v204, v204, v231, v232
  v_max3_u32 v204, v204, v233, v234
  v_max3_u32 v204, v204, v235, v236
  v_max3_u32 v204, v204, v237, v238
  v_max3_u32 v204, v204, v239, v240
  v_max3_u32 v204, v204, v241, v242
  v_max3_u32 v204, v204, v243, v244
  v_max3_u32 v204, v204, v245, v246
  v_max3_u32 v204, v204, v247, v248
  v_max3_u32 v204, v204, v249, v250
  v_max3_u32 v204, v204, v251, v252
  v_max3_u32 v204, v204, v253, v254
  v_max_u32 v204, v204, v255
  v_cmp_eq_u32 vcc, -1, v204
  s_nop 3
  s_cbranch_vccnz VLP_61
  s_branch VOK_60
OVOK_63:
VLP_64:
  s_cmp_eq_u32 s0, 0
  s_cbranch_scc1 VOK_63
  s_sub_u32 s0, s0, 1
  s_waitcnt vmcnt(0)
  s_sleep 2
  s_add_u32 s97, s85, 32768
  buffer_load_dwordx4 v[160:163], v1, s[40:43], s97 offen offset:0 sc1
  s_add_u32 s97, s85, 32768
  buffer_load_dwordx4 v[164:167], v1, s[40:43], s97 offen offset:1024 sc1
  s_add_u32 s97, s86, 32768
  buffer_load_dwordx4 v[168:171], v1, s[40:43], s97 offen offset:0 sc1
  s_add_u32 s97, s86, 32768
  buffer_load_dwordx4 v[172:175], v1, s[40:43], s97 offen offset:1024 sc1
  s_add_u32 s97, s87, 32768
  buffer_load_dwordx4 v[176:179], v1, s[40:43], s97 offen offset:0 sc1
  s_add_u32 s97, s87, 32768
  buffer_load_dwordx4 v[180:183], v1, s[40:43], s97 offen offset:1024 sc1
  s_add_u32 s97, s88, 32768
  buffer_load_dwordx4 v[184:187], v1, s[40:43], s97 offen offset:0 sc1
  s_add_u32 s97, s88, 32768
  buffer_load_dwordx4 v[188:191], v1, s[40:43], s97 offen offset:1024 sc1
  s_add_u32 s97, s85, 65536
  buffer_load_dwordx4 v[192:195], v1, s[40:43], s97 offen offset:0 sc1
  s_waitcnt vmcnt(0)
  v_max3_u32 v26, v160, v161, v162
  v_max3_u32 v26, v26, v163, v164
  v_max3_u32 v26, v26, v165, v166
  v_max_u32 v26, v26, v167
  v_cmp_eq_u32 vcc, -1, v26
  s_nop 3
  s_cbranch_vccnz VLP_64
  s_branch VOK_63
OVOK_65:
VLP_66:
  s_cmp_eq_u32 s0, 0
  s_cbranch_scc1 VOK_65
  s_sub_u32 s0, s0, 1
  s_waitcnt vmcnt(0)
  s_sleep 2
  s_add_u32 s97, s86, 32768
  buffer_load_dwordx4 v[168:171], v1, s[40:43], s97 offen offset:0 sc1
  s_add_u32 s97, s86, 32768
  buffer_load_dwordx4 v[172:175], v1, s[40:43], s97 offen offset:1024 sc1
  s_add_u32 s97, s87, 32768
  buffer_load_dwordx4 v[176:179], v1, s[40:43], s97 offen offset:0 sc1
  s_add_u32 s97, s87, 32768
  buffer_load_dwordx4 v[180:183], v1, s[40:43], s97 offen offset:1024 sc1
  s_add_u32 s97, s88, 32768
  buffer_load_dwordx4 v[184:187], v1, s[40:43], s97 offen offset:0 sc1
  s_add_u32 s97, s88, 32768
  buffer_load_dwordx4 v[188:191], v1, s[40:43], s97 offen offset:1024 sc1
  s_add_u32 s97, s85, 65536
  buffer_load_dwordx4 v[192:195], v1, s[40:43], s97 offen offset:0 sc1
  s_add_u32 s97, s85, 65536
  buffer_load_dwordx4 v[196:199], v1, s[40:43], s97 offen offset:1024 sc1
  s_add_u32 s97, s86, 65536
  buffer_load_dwordx4 v[200:203], v1, s[40:43], s97 offen offset:0 sc1
  s_add_u32 s97, s86, 65536
  buffer_load_dwordx4 v[204:207], v1, s[40:43], s97 offen offset:1024 sc1
  s_waitcnt vmcnt(0)
  v_max3_u32 v26, v168, v169, v170
  v_max3_u32 v26, v26, v171, v172
  v_max3_u32 v26, v26, v173, v174
  v_max_u32 v26, v26, v175
  v_cmp_eq_u32 vcc, -1, v26
  s_nop 3
  s_cbranch_vccnz VLP_66
  s_branch VOK_65
OVOK_67:
VLP_68:
  s_cmp_eq_u32 s0, 0
  s_cbranch_scc1 VOK_67
  s_sub_u32 s0, s0, 1
  s_waitcnt vmcnt(0)
  s_sleep 2
  s_add_u32 s97, s87, 32768
  buffer_load_dwordx4 v[176:179], v1, s[40:43], s97 offen offset:0 sc1
  s_add_u32 s97, s87, 32768
  buffer_load_dwordx4 v[180:183], v1, s[40:43], s97 offen offset:1024 sc1
  s_add_u32 s97, s88, 32768
  buffer_load_dwordx4 v[184:187], v1, s[40:43], s97 offen offset:0 sc1
  s_add_u32 s97, s88, 32768
  buffer_load_dwordx4 v[188:191], v1, s[40:43], s97 offen offset:1024 sc1
  s_add_u32 s97, s85, 65536
  buffer_load_dwordx4 v[192:195], v1, s[40:43], s97 offen offset:0 sc1
  s_add_u32 s97, s85, 65536
  buffer_load_dwordx4 v[196:199], v1, s[40:43], s97 offen offset:1024 sc1
  s_add_u32 s97, s86, 65536
  buffer_load_dwordx4 v[200:203], v1, s[40:43], s97 offen offset:0 sc1
  s_add_u32 s97, s86, 65536
  buffer_load_dwordx4 v[204:207], v1, s[40:43], s97 offen offset:1024 sc1
  s_add_u32 s97, s87, 65536
  buffer_load_dwordx4 v[208:211], v1, s[40:43], s97 offen offset:0 sc1
  s_waitcnt vmcnt(0)
  v_max3_u32 v26, v176, v177, v178
  v_max3_u32 v26, v26, v179, v180
  v_max3_u32 v26, v26, v181, v182
  v_max_u32 v26, v26, v183
  v_cmp_eq_u32 vcc, -1, v26
  s_nop 3
  s_cbranch_vccnz VLP_68
  s_branch VOK_67
OVOK_69:
VLP_70:
  s_cmp_eq_u32 s0, 0
  s_cbranch_scc1 VOK_69
  s_sub_u32 s0, s0, 1
  s_waitcnt vmcnt(0)
  s_sleep 2
  s_add_u32 s97, s88, 32768
  buffer_load_dwordx4 v[184:187], v1, s[40:43], s97 offen offset:0 sc1
  s_add_u32 s97, s88, 32768
  buffer_load_dwordx4 v[188:191], v1, s[40:43], s97 offen offset:1024 sc1
  s_add_u32 s97, s85, 65536
  buffer_load_dwordx4 v[192:195], v1, s[40:43], s97 offen offset:0 sc1
  s_add_u32 s97, s85, 65536
  buffer_load_dwordx4 v[196:199], v1, s[40:43], s97 offen offset:1024 sc1
  s_add_u32 s97, s86, 65536
  buffer_load_dwordx4 v[200:203], v1, s[40:43], s97 offen offset:0 sc1
  s_add_u32 s97, s86, 65536
  buffer_load_dwordx4 v[204:207], v1, s[40:43], s97 offen offset:1024 sc1
  s_add_u32 s97, s87, 65536
  buffer_load_dwordx4 v[208:211], v1, s[40:43], s97 offen offset:0 sc1
  s_add_u32 s97, s87, 65536
  buffer_load_dwordx4 v[212:215], v1, s[40:43], s97 offen offset:1024 sc1
  s_add_u32 s97, s88, 65536
  buffer_load_dwordx4 v[216:219], v1, s[40:43], s97 offen offset:0 sc1
  s_waitcnt vmcnt(0)
  v_max3_u32 v26, v184, v185, v186
  v_max3_u32 v26, v26, v187, v188
  v_max3_u32 v26, v26, v189, v190
  v_max_u32 v26, v26, v191
  v_cmp_eq_u32 vcc, -1, v26
  s_nop 3
  s_cbranch_vccnz VLP_70
  s_branch VOK_69
OVOK_71:
VLP_72:
  s_cmp_eq_u32 s0, 0
  s_cbranch_scc1 VOK_71
  s_sub_u32 s0, s0, 1
  s_waitcnt vmcnt(0)
  s_sleep 2
  s_add_u32 s97, s85, 65536
  buffer_load_dwordx4 v[192:195], v1, s[40:43], s97 offen offset:0 sc1
  s_add_u32 s97, s85, 65536
  buffer_load_dwordx4 v[196:199], v1, s[40:43], s97 offen offset:1024 sc1
  s_add_u32 s97, s86, 65536
  buffer_load_dwordx4 v[200:203], v1, s[40:43], s97 offen offset:0 sc1
  s_add_u32 s97, s86, 65536
  buffer_load_dwordx4 v[204:207], v1, s[40:43], s97 offen offset:1024 sc1
  s_add_u32 s97, s87, 65536
  buffer_load_dwordx4 v[208:211], v1, s[40:43], s97 offen offset:0 sc1
  s_add_u32 s97, s87, 65536
  buffer_load_dwordx4 v[212:215], v1, s[40:43], s97 offen offset:1024 sc1
  s_add_u32 s97, s88, 65536
  buffer_load_dwordx4 v[216:219], v1, s[40:43], s97 offen offset:0 sc1
  s_add_u32 s97, s88, 65536
  buffer_load_dwordx4 v[220:223], v1, s[40:43], s97 offen offset:1024 sc1
  s_waitcnt vmcnt(0)
  v_max3_u32 v26, v192, v193, v194
  v_max3_u32 v26, v26, v195, v196
  v_max3_u32 v26, v26, v197, v198
  v_max_u32 v26, v26, v199
  v_cmp_eq_u32 vcc, -1, v26
  s_nop 3
  s_cbranch_vccnz VLP_72
  s_branch VOK_71
OVOK_73:
VLP_74:
  s_cmp_eq_u32 s0, 0
  s_cbranch_scc1 VOK_73
  s_sub_u32 s0, s0, 1
  s_waitcnt vmcnt(0)
  s_sleep 2
  s_add_u32 s97, s86, 65536
  buffer_load_dwordx4 v[200:203], v1, s[40:43], s97 offen offset:0 sc1
  s_add_u32 s97, s86, 65536
  buffer_load_dwordx4 v[204:207], v1, s[40:43], s97 offen offset:1024 sc1
  s_add_u32 s97, s87, 65536
  buffer_load_dwordx4 v[208:211], v1, s[40:43], s97 offen offset:0 sc1
  s_add_u32 s97, s87, 65536
  buffer_load_dwordx4 v[212:215], v1, s[40:43], s97 offen offset:1024 sc1
  s_add_u32 s97, s88, 65536
  buffer_load_dwordx4 v[216:219], v1, s[40:43], s97 offen offset:0 sc1
  s_add_u32 s97, s88, 65536
  buffer_load_dwordx4 v[220:223], v1, s[40:43], s97 offen offset:1024 sc1
  s_add_u32 s97, s89, 98304
  buffer_load_dwordx4 v[224:227], v1, s[40:43], s97 offen offset:0 sc1
  s_add_u32 s97, s89, 98304
  buffer_load_dwordx4 v[228:231], v1, s[40:43], s97 offen offset:1024 sc1
  s_waitcnt vmcnt(0)
  v_max3_u32 v26, v200, v201, v202
  v_max3_u32 v26, v26, v203, v204
  v_max3_u32 v26, v26, v205, v206
  v_max_u32 v26, v26, v207
  v_cmp_eq_u32 vcc, -1, v26
  s_nop 3
  s_cbranch_vccnz VLP_74
  s_branch VOK_73
OVOK_75:
VLP_76:
  s_cmp_eq_u32 s0, 0
  s_cbranch_scc1 VOK_75
  s_sub_u32 s0, s0, 1
  s_waitcnt vmcnt(0)
  s_sleep 2
  s_add_u32 s97, s87, 65536
  buffer_load_dwordx4 v[208:211], v1, s[40:43], s97 offen offset:0 sc1
  s_add_u32 s97, s87, 65536
  buffer_load_dwordx4 v[212:215], v1, s[40:43], s97 offen offset:1024 sc1
  s_add_u32 s97, s88, 65536
  buffer_load_dwordx4 v[216:219], v1, s[40:43], s97 offen offset:0 sc1
  s_add_u32 s97, s88, 65536
  buffer_load_dwordx4 v[220:223], v1, s[40:43], s97 offen offset:1024 sc1
  s_add_u32 s97, s89, 98304
  buffer_load_dwordx4 v[224:227], v1, s[40:43], s97 offen offset:0 sc1
  s_add_u32 s97, s89, 98304
  buffer_load_dwordx4 v[228:231], v1, s[40:43], s97 offen offset:1024 sc1
  s_add_u32 s97, s90, 98304
  buffer_load_dwordx4 v[232:235], v1, s[40:43], s97 offen offset:0 sc1
  s_add_u32 s97, s90, 98304
  buffer_load_dwordx4 v[236:239], v1, s[40:43], s97 offen offset:1024 sc1
  s_waitcnt vmcnt(0)
  v_max3_u32 v26, v208, v209, v210
  v_max3_u32 v26, v26, v211, v212
  v_max3_u32 v26, v26, v213, v214
  v_max_u32 v26, v26, v215
  v_cmp_eq_u32 vcc, -1, v26
  s_nop 3
  s_cbranch_vccnz VLP_76
  s_branch VOK_75
OVOK_77:
VLP_78:
  s_cmp_eq_u32 s0, 0
  s_cbranch_scc1 VOK_77
  s_sub_u32 s0, s0, 1
  s_waitcnt vmcnt(0)
  s_sleep 2
  s_add_u32 s97, s88, 65536
  buffer_load_dwordx4 v[216:219], v1, s[40:43], s97 offen offset:0 sc1
  s_add_u32 s97, s88, 65536
  buffer_load_dwordx4 v[220:223], v1, s[40:43], s97 offen offset:1024 sc1
  s_add_u32 s97, s89, 98304
  buffer_load_dwordx4 v[224:227], v1, s[40:43], s97 offen offset:0 sc1
  s_add_u32 s97, s89, 98304
  buffer_load_dwordx4 v[228:231], v1, s[40:43], s97 offen offset:1024 sc1
  s_add_u32 s97, s90, 98304
  buffer_load_dwordx4 v[232:235], v1, s[40:43], s97 offen offset:0 sc1
  s_add_u32 s97, s90, 98304
  buffer_load_dwordx4 v[236:239], v1, s[40:43], s97 offen offset:1024 sc1
  s_add_u32 s97, s85, 114688
  buffer_load_dwordx4 v[240:243], v1, s[40:43], s97 offen offset:0 sc1
  s_waitcnt vmcnt(0)
  v_max3_u32 v26, v216, v217, v218
  v_max3_u32 v26, v26, v219, v220
  v_max3_u32 v26, v26, v221, v222
  v_max_u32 v26, v26, v223
  v_cmp_eq_u32 vcc, -1, v26
  s_nop 3
  s_cbranch_vccnz VLP_78
  s_branch VOK_77
OVOK_79:
VLP_80:
  s_cmp_eq_u32 s0, 0
  s_cbranch_scc1 VOK_79
  s_sub_u32 s0, s0, 1
  s_waitcnt vmcnt(0)
  s_sleep 2
  s_add_u32 s97, s89, 98304
  buffer_load_dwordx4 v[224:227], v1, s[40:43], s97 offen offset:0 sc1
  s_add_u32 s97, s89, 98304
  buffer_load_dwordx4 v[228:231], v1, s[40:43], s97 offen offset:1024 sc1
  s_add_u32 s97, s90, 98304
  buffer_load_dwordx4 v[232:235], v1, s[40:43], s97 offen offset:0 sc1
  s_add_u32 s97, s90, 98304
  buffer_load_dwordx4 v[236:239], v1, s[40:43], s97 offen offset:1024 sc1
  s_add_u32 s97, s85, 114688
  buffer_load_dwordx4 v[240:243], v1, s[40:43], s97 offen offset:0 sc1
  s_add_u32 s97, s85, 114688
  buffer_load_dwordx4 v[244:247], v1, s[40:43], s97 offen offset:1024 sc1
  s_add_u32 s97, s86, 114688
  buffer_load_dwordx4 v[248:251], v1, s[40:43], s97 offen offset:0 sc1
  s_waitcnt vmcnt(0)
  v_max3_u32 v26, v224, v225, v226
  v_max3_u32 v26, v26, v227, v228
  v_max3_u32 v26, v26, v229, v230
  v_max_u32 v26, v26, v231
  v_cmp_eq_u32 vcc, -1, v26
  s_nop 3
  s_cbranch_vccnz VLP_80
  s_branch VOK_79
OVOK_81:
VLP_82:
  s_cmp_eq_u32 s0, 0
  s_cbranch_scc1 VOK_81
  s_sub_u32 s0, s0, 1
  s_waitcnt vmcnt(0)
  s_sleep 2
  s_add_u32 s97, s90, 98304
  buffer_load_dwordx4 v[232:235], v1, s[40:43], s97 offen offset:0 sc1
  s_add_u32 s97, s90, 98304
  buffer_load_dwordx4 v[236:239], v1, s[40:43], s97 offen offset:1024 sc1
  s_add_u32 s97, s85, 114688
  buffer_load_dwordx4 v[240:243], v1, s[40:43], s97 offen offset:0 sc1
  s_add_u32 s97, s85, 114688
  buffer_load_dwordx4 v[244:247], v1, s[40:43], s97 offen offset:1024 sc1
  s_add_u32 s97, s86, 114688
  buffer_load_dwordx4 v[248:251], v1, s[40:43], s97 offen offset:0 sc1
  s_add_u32 s97, s86, 114688
  buffer_load_dwordx4 v[252:255], v1, s[40:43], s97 offen offset:1024 sc1
  s_add_u32 s97, s87, 114688
  buffer_load_dwordx4 v[128:131], v1, s[40:43], s97 offen offset:0 sc1
  s_waitcnt vmcnt(0)
  v_max3_u32 v26, v232, v233, v234
  v_max3_u32 v26, v26, v235, v236
  v_max3_u32 v26, v26, v237, v238
  v_max_u32 v26, v26, v239
  v_cmp_eq_u32 vcc, -1, v26
  s_nop 3
  s_cbranch_vccnz VLP_82
  s_branch VOK_81
OVOK_83:
VLP_84:
  s_cmp_eq_u32 s0, 0
  s_cbranch_scc1 VOK_83
  s_sub_u32 s0, s0, 1
  s_waitcnt vmcnt(0)
  s_sleep 2
  s_add_u32 s97, s85, 114688
  buffer_load_dwordx4 v[240:243], v1, s[40:43], s97 offen offset:0 sc1
  s_add_u32 s97, s85, 114688
  buffer_load_dwordx4 v[244:247], v1, s[40:43], s97 offen offset:1024 sc1
  s_add_u32 s97, s86, 114688
  buffer_load_dwordx4 v[248:251], v1, s[40:43], s97 offen offset:0 sc1
  s_add_u32 s97, s86, 114688
  buffer_load_dwordx4 v[252:255], v1, s[40:43], s97 offen offset:1024 sc1
  s_add_u32 s97, s87, 114688
  buffer_load_dwordx4 v[128:131], v1, s[40:43], s97 offen offset:0 sc1
  s_add_u32 s97, s87, 114688
  buffer_load_dwordx4 v[132:135], v1, s[40:43], s97 offen offset:1024 sc1
  s_add_u32 s97, s88, 114688
  buffer_load_dwordx4 v[136:139], v1, s[40:43], s97 offen offset:0 sc1
  s_add_u32 s97, s88, 114688
  buffer_load_dwordx4 v[140:143], v1, s[40:43], s97 offen offset:1024 sc1
  s_waitcnt vmcnt(0)
  v_max3_u32 v26, v240, v241, v242
  v_max3_u32 v26, v26, v243, v244
  v_max3_u32 v26, v26, v245, v246
  v_max_u32 v26, v26, v247
  v_cmp_eq_u32 vcc, -1, v26
  s_nop 3
  s_cbranch_vccnz VLP_84
  s_branch VOK_83
OVOK_85:
VLP_86:
  s_cmp_eq_u32 s0, 0
  s_cbranch_scc1 VOK_85
  s_sub_u32 s0, s0, 1
  s_waitcnt vmcnt(0)
  s_sleep 2
  s_add_u32 s97, s86, 114688
  buffer_load_dwordx4 v[248:251], v1, s[40:43], s97 offen offset:0 sc1
  s_add_u32 s97, s86, 114688
  buffer_load_dwordx4 v[252:255], v1, s[40:43], s97 offen offset:1024 sc1
  s_add_u32 s97, s87, 114688
  buffer_load_dwordx4 v[128:131], v1, s[40:43], s97 offen offset:0 sc1
  s_add_u32 s97, s87, 114688
  buffer_load_dwordx4 v[132:135], v1, s[40:43], s97 offen offset:1024 sc1
  s_add_u32 s97, s88, 114688
  buffer_load_dwordx4 v[136:139], v1, s[40:43], s97 offen offset:0 sc1
  s_add_u32 s97, s88, 114688
  buffer_load_dwordx4 v[140:143], v1, s[40:43], s97 offen offset:1024 sc1
  s_waitcnt vmcnt(0)
  v_max3_u32 v26, v248, v249, v250
  v_max3_u32 v26, v26, v251, v252
  v_max3_u32 v26, v26, v253, v254
  v_max_u32 v26, v26, v255
  v_cmp_eq_u32 vcc, -1, v26
  s_nop 3
  s_cbranch_vccnz VLP_86
  s_branch VOK_85
OVOK_87:
VLP_88:
  s_cmp_eq_u32 s0, 0
  s_cbranch_scc1 VOK_87
  s_sub_u32 s0, s0, 1
  s_waitcnt vmcnt(0)
  s_sleep 2
  s_add_u32 s97, s87, 114688
  buffer_load_dwordx4 v[128:131], v1, s[40:43], s97 offen offset:0 sc1
  s_add_u32 s97, s87, 114688
  buffer_load_dwordx4 v[132:135], v1, s[40:43], s97 offen offset:1024 sc1
  s_add_u32 s97, s88, 114688
  buffer_load_dwordx4 v[136:139], v1, s[40:43], s97 offen offset:0 sc1
  s_add_u32 s97, s88, 114688
  buffer_load_dwordx4 v[140:143], v1, s[40:43], s97 offen offset:1024 sc1
  s_waitcnt vmcnt(0)
  v_max3_u32 v26, v128, v129, v130
  v_max3_u32 v26, v26, v131, v132
  v_max3_u32 v26, v26, v133, v134
  v_max_u32 v26, v26, v135
  v_cmp_eq_u32 vcc, -1, v26
  s_nop 3
  s_cbranch_vccnz VLP_88
  s_branch VOK_87
OVOK_89:
VLP_90:
  s_cmp_eq_u32 s0, 0
  s_cbranch_scc1 VOK_89
  s_sub_u32 s0, s0, 1
  s_waitcnt vmcnt(0)
  s_sleep 2
  s_add_u32 s97, s88, 114688
  buffer_load_dwordx4 v[136:139], v1, s[40:43], s97 offen offset:0 sc1
  s_add_u32 s97, s88, 114688
  buffer_load_dwordx4 v[140:143], v1, s[40:43], s97 offen offset:1024 sc1
  s_waitcnt vmcnt(0)
  v_max3_u32 v26, v136, v137, v138
  v_max3_u32 v26, v26, v139, v140
  v_max3_u32 v26, v26, v141, v142
  v_max_u32 v26, v26, v143
  v_cmp_eq_u32 vcc, -1, v26
  s_nop 3
  s_cbranch_vccnz VLP_90
  s_branch VOK_89
L_END:
  s_endpgm
.section .rodata,"a"
.p2align 6
.amdhsa_kernel parallel_sum__linear_kernel_hedgehog__glu_gated_glu__prompt_kernel
  .amdhsa_next_free_vgpr 256
  .amdhsa_next_free_sgpr 102
  .amdhsa_accum_offset 256
  .amdhsa_group_segment_fixed_size 0
  .amdhsa_kernarg_size 88
  .amdhsa_user_sgpr_count 2
  .amdhsa_user_sgpr_kernarg_segment_ptr 1
  .amdhsa_system_sgpr_workgroup_id_x 1
.end_amdhsa_kernel
```
